```python
import torch

def _softmax(x, axis=-1):
    return torch.softmax(x, dim=axis)
def _gelu(x):
    return torch.nn.functional.gelu(x, approximate="tanh")
def _silu(x):
    return torch.nn.functional.silu(x)
def _sigmoid(x):
    return torch.sigmoid(x)
def _layernorm(x, axis=-1, eps=1e-5):
    m = x.mean(dim=axis, keepdim=True)
    v = x.var(dim=axis, keepdim=True, unbiased=False)
    return (x - m) / torch.sqrt(v + eps)
def _scatter_add(tgt, idx, src, axis=0):
    return tgt.clone().index_add_(axis, idx, src)
def _segment_sum(src, seg, n):
    out = torch.zeros((n,) + src.shape[1:], dtype=src.dtype)
    return out.index_add_(0, seg, src)
def _pad(x, pw):
    flat = tuple(v for pair in reversed(pw) for v in pair)
    return torch.nn.functional.pad(x, flat)

kernel_name = 'sequential_preLN__sliding_local_dilated__mixer_token_mlp__prompt'

def setup_inputs():

    _w = (lambda a: (lambda t: t.to(torch.bfloat16) if t.is_floating_point() else t)(torch.as_tensor(a)))
    def _A_setup():
        B, S, D = 1, 2048, 640
        return {
            "x": _w((lambda *s: torch.randn(*s, dtype=torch.bfloat16) * 0.05)(B, S, D)),
            "wqkv": _w((lambda *s: torch.randn(*s, dtype=torch.bfloat16) * 0.05)(D, 3 * D)),
            "wo": _w((lambda *s: torch.randn(*s, dtype=torch.bfloat16) * 0.05)(D, D)),
        }
    _A_in = _A_setup()

    def _B_setup():
        B, S, D, F = 1, 2048, 640, 1536
        return {
            "x": _w((lambda *s: torch.randn(*s, dtype=torch.bfloat16) * 0.05)(B, S, D)),
            "w1": _w((lambda *s: torch.randn(*s, dtype=torch.bfloat16) * 0.8)(S, F) * (S ** -0.5)),
            "b1": _w((lambda *s: torch.randn(*s, dtype=torch.bfloat16) * 0.8)(F) * 0.02),
            "w2": _w((lambda *s: torch.randn(*s, dtype=torch.bfloat16) * 0.8)(F, S) * (F ** -0.5)),
            "b2": _w((lambda *s: torch.randn(*s, dtype=torch.bfloat16) * 0.8)(S) * 0.02),
        }
    _B_in = _B_setup()

    return {
        "A_x": _A_in["x"],
        "A_wqkv": _A_in["wqkv"],
        "A_wo": _A_in["wo"],
        "B_x": _B_in["x"],
        "B_w1": _B_in["w1"],
        "B_b1": _B_in["b1"],
        "B_w2": _B_in["w2"],
        "B_b2": _B_in["b2"],
    }

def reference(A_x, A_wqkv, A_wo, B_x, B_w1, B_b1, B_w2, B_b2):
    def _A_ref(x, wqkv, wo):
        B, S, D = x.shape
        H = 32; Dh = D // H
        W, dil = 8, 2
        qkv = (lambda x, *d: x.permute(*d))((x @ wqkv).reshape(B, S, 3, H, Dh), 2, 0, 3, 1, 4)
        q, k, v = qkv[0], qkv[1], qkv[2]
        scale = Dh ** -0.5
        pos = torch.arange(S)
        off = torch.arange(W) * dil
        idx = pos[:, None] - off[None, :]
        mask = idx >= 0
        idx_c = torch.where(mask, idx, 0).reshape(-1)
        kg = k[:, :, idx_c, :].reshape(B, H, S, W, Dh)
        vg = v[:, :, idx_c, :].reshape(B, H, S, W, Dh)
        logits = torch.einsum("bhsd,bhswd->bhsw", q, kg) * scale
        logits = torch.where(mask[None, None, :, :], logits, -1e9)
        attn = _softmax(logits, axis=-1)
        o = torch.einsum("bhsw,bhswd->bhsd", attn, vg)
        return (lambda x, *d: x.permute(*d))(o, 0, 2, 1, 3).reshape(B, S, D) @ wo

    def _B_ref(x, w1, b1, w2, b2):
        B, S, D = x.shape
        h = _layernorm(x, axis=-1)
        u = torch.einsum("bsd,sf->bdf", h, w1) + b1
        u = _gelu(u)
        y = torch.einsum("bdf,fs->bds", u, w2) + b2
        return (lambda x, *d: x.permute(*d))(y, 0, 2, 1)

    x = A_x
    h = x + _A_ref(_layernorm(x, axis=-1), A_wqkv, A_wo)
    h2 = h + _B_ref(_layernorm(h, axis=-1), B_w1, B_b1, B_w2, B_b2)
    return h2
```

```asm
; @launch grid=(256,1,1) block=(256,1,1) lds=163840
.amdgcn_target "amdgcn-amd-amdhsa--gfx950"
.text
.globl sequential_preLN__sliding_local_dilated__mixer_token_mlp__prompt_kernel
.p2align 8
.type sequential_preLN__sliding_local_dilated__mixer_token_mlp__prompt_kernel,@function
sequential_preLN__sliding_local_dilated__mixer_token_mlp__prompt_kernel:
    s_cmp_ge_u32 s2, 256
    s_cbranch_scc1 L_end
    s_load_dwordx4 s[4:7], s[0:1], 0
    s_load_dwordx2 s[10:11], s[0:1], 16
    s_load_dwordx4 s[12:15], s[0:1], 32
    s_load_dwordx4 s[16:19], s[0:1], 48
    s_load_dwordx4 s[20:23], s[0:1], 64
    s_load_dwordx2 s[8:9], s[0:1], 80

    v_lshrrev_b32 v2, 6, v0
    v_and_b32 v1, 63, v0
    v_readfirstlane_b32 s44, v2
    s_and_b32 s50, s2, 7
    s_lshr_b32 s51, s2, 3

    s_lshr_b32 s52, s50, 1
    s_lshl_b32 s52, s52, 3
    s_lshr_b32 s49, s51, 2
    s_add_u32 s52, s52, s49
    s_and_b32 s53, s50, 1
    s_lshl_b32 s53, s53, 2
    s_and_b32 s49, s51, 3
    s_add_u32 s53, s53, s49
    s_mul_i32 s54, s52, 81920
    s_mul_i32 s49, s44, 10240
    s_add_u32 s54, s54, s49
    s_sub_u32 s54, s54, 20480
    s_lshl_b32 s49, s52, 2
    s_add_u32 s49, s49, s44
    s_cmp_lt_u32 s49, 2
    s_cselect_b32 s55, 0x7ff00000, s54
    s_lshl_b32 s56, s44, 10
    s_cmp_eq_u32 s44, 0
    s_cselect_b32 s68, 0xffffff00, -1
    s_mov_b32 s69, -1
    s_lshr_b32 s40, s51, 2
    s_and_b32 s41, s51, 3
    s_mul_i32 s41, s41, 3
    s_add_u32 s40, s40, s41
    s_and_b32 s41, s50, 1
    s_mul_i32 s41, s41, 4
    s_add_u32 s40, s40, s41
    s_add_u32 s40, s40, s50
    s_mul_i32 s41, s40, 103
    s_lshr_b32 s41, s41, 10
    s_mul_i32 s41, s41, 10
    s_sub_u32 s40, s40, s41

    s_lshl_b32 s45, s40, 7
    s_mul_i32 s46, s40, 245760
    s_mul_i32 s49, s53, 160
    s_add_u32 s46, s46, s49
    v_and_b32 v7, 15, v1
    v_lshrrev_b32 v6, 4, v1
    s_and_b32 s49, s44, 1
    s_lshl_b32 s49, s49, 2
    v_add_u32 v2, s49, v6
    v_and_b32 v3, 7, v1
    v_xor_b32 v3, v2, v3
    v_lshlrev_b32 v3, 4, v3
    v_lshrrev_b32 v2, 3, v1
    v_mul_u32_u24 v2, 1280, v2
    v_add_u32 v16, v2, v3
    s_lshl_b32 s57, s44, 6
    v_add_u32 v30, s57, v1

    v_add_u32 v2, 0, v30
    v_mul_u32_u24 v3, 2185, v2
    v_lshrrev_b32 v3, 16, v3
    v_mul_u32_u24 v31, 30, v3
    v_sub_u32 v4, v2, v31
    v_mul_u32_u24 v5, 13, v4
    v_lshrrev_b32 v5, 7, v5
    v_mul_u32_u24 v31, 10, v5
    v_sub_u32 v4, v4, v31
    v_mul_u32_u24 v5, 1280, v5
    v_lshl_add_u32 v5, v4, 4, v5
    v_and_b32 v4, 0x33, v3
    v_bfe_u32 v2, v3, 2, 1
    v_lshl_or_b32 v4, v2, 3, v4
    v_bfe_u32 v2, v3, 3, 1
    v_lshl_or_b32 v4, v2, 2, v4
    s_movk_i32 s49, 3840
    v_mad_u32_u24 v8, v4, s49, v5

    v_add_u32 v2, 256, v30
    v_mul_u32_u24 v3, 2185, v2
    v_lshrrev_b32 v3, 16, v3
    v_mul_u32_u24 v31, 30, v3
    v_sub_u32 v4, v2, v31
    v_mul_u32_u24 v5, 13, v4
    v_lshrrev_b32 v5, 7, v5
    v_mul_u32_u24 v31, 10, v5
    v_sub_u32 v4, v4, v31
    v_mul_u32_u24 v5, 1280, v5
    v_lshl_add_u32 v5, v4, 4, v5
    v_and_b32 v4, 0x33, v3
    v_bfe_u32 v2, v3, 2, 1
    v_lshl_or_b32 v4, v2, 3, v4
    v_bfe_u32 v2, v3, 3, 1
    v_lshl_or_b32 v4, v2, 2, v4
    s_movk_i32 s49, 3840
    v_mad_u32_u24 v9, v4, s49, v5

    s_waitcnt lgkmcnt(0)
    s_mov_b32 s24, s4
    s_mov_b32 s25, s5
    s_mov_b32 s26, 0x280000
    s_mov_b32 s27, 0x00020000
    s_mov_b32 s28, s6
    s_mov_b32 s29, s7
    s_mov_b32 s30, 0x258000
    s_mov_b32 s31, 0x00020000
    s_add_u32 m0, s56, 0
    s_add_u32 s57, s55, s45
    s_mov_b64 exec, s[68:69]
    buffer_load_dwordx4 v16, s[24:27], s57 offen lds
    s_mov_b64 exec, -1
    s_add_u32 m0, s56, 4096
    s_add_u32 s57, s54, 40960
    s_add_u32 s57, s57, s45
    buffer_load_dwordx4 v16, s[24:27], s57 offen lds
    s_add_u32 m0, s56, 10240
    s_nop 0
    buffer_load_dwordx4 v8, s[28:31], s46 offen lds
    s_add_u32 m0, s56, 14336
    s_nop 0
    buffer_load_dwordx4 v9, s[28:31], s46 offen lds
    v_add_u32 v2, 512, v30
    v_mul_u32_u24 v3, 2185, v2
    v_lshrrev_b32 v3, 16, v3
    v_mul_u32_u24 v31, 30, v3
    v_sub_u32 v4, v2, v31
    v_mul_u32_u24 v5, 13, v4
    v_lshrrev_b32 v5, 7, v5
    v_mul_u32_u24 v31, 10, v5
    v_sub_u32 v4, v4, v31
    v_mul_u32_u24 v5, 1280, v5
    v_lshl_add_u32 v5, v4, 4, v5
    v_and_b32 v4, 0x33, v3
    v_bfe_u32 v2, v3, 2, 1
    v_lshl_or_b32 v4, v2, 3, v4
    v_bfe_u32 v2, v3, 3, 1
    v_lshl_or_b32 v4, v2, 2, v4
    s_movk_i32 s49, 3840
    v_mad_u32_u24 v10, v4, s49, v5

    s_add_u32 m0, s56, 18432
    s_nop 0
    buffer_load_dwordx4 v10, s[28:31], s46 offen lds
    v_add_u32 v2, 768, v30
    v_mul_u32_u24 v3, 2185, v2
    v_lshrrev_b32 v3, 16, v3
    v_mul_u32_u24 v31, 30, v3
    v_sub_u32 v4, v2, v31
    v_mul_u32_u24 v5, 13, v4
    v_lshrrev_b32 v5, 7, v5
    v_mul_u32_u24 v31, 10, v5
    v_sub_u32 v4, v4, v31
    v_mul_u32_u24 v5, 1280, v5
    v_lshl_add_u32 v5, v4, 4, v5
    v_and_b32 v4, 0x33, v3
    v_bfe_u32 v2, v3, 2, 1
    v_lshl_or_b32 v4, v2, 3, v4
    v_bfe_u32 v2, v3, 3, 1
    v_lshl_or_b32 v4, v2, 2, v4
    s_movk_i32 s49, 3840
    v_mad_u32_u24 v11, v4, s49, v5

    s_add_u32 m0, s56, 22528
    s_nop 0
    buffer_load_dwordx4 v11, s[28:31], s46 offen lds
    v_add_u32 v2, 1024, v30
    v_mul_u32_u24 v3, 2185, v2
    v_lshrrev_b32 v3, 16, v3
    v_mul_u32_u24 v31, 30, v3
    v_sub_u32 v4, v2, v31
    v_mul_u32_u24 v5, 13, v4
    v_lshrrev_b32 v5, 7, v5
    v_mul_u32_u24 v31, 10, v5
    v_sub_u32 v4, v4, v31
    v_mul_u32_u24 v5, 1280, v5
    v_lshl_add_u32 v5, v4, 4, v5
    v_and_b32 v4, 0x33, v3
    v_bfe_u32 v2, v3, 2, 1
    v_lshl_or_b32 v4, v2, 3, v4
    v_bfe_u32 v2, v3, 3, 1
    v_lshl_or_b32 v4, v2, 2, v4
    s_movk_i32 s49, 3840
    v_mad_u32_u24 v12, v4, s49, v5

    s_add_u32 m0, s56, 26624
    s_nop 0
    buffer_load_dwordx4 v12, s[28:31], s46 offen lds
    v_add_u32 v2, 1280, v30
    v_mul_u32_u24 v3, 2185, v2
    v_lshrrev_b32 v3, 16, v3
    v_mul_u32_u24 v31, 30, v3
    v_sub_u32 v4, v2, v31
    v_mul_u32_u24 v5, 13, v4
    v_lshrrev_b32 v5, 7, v5
    v_mul_u32_u24 v31, 10, v5
    v_sub_u32 v4, v4, v31
    v_mul_u32_u24 v5, 1280, v5
    v_lshl_add_u32 v5, v4, 4, v5
    v_and_b32 v4, 0x33, v3
    v_bfe_u32 v2, v3, 2, 1
    v_lshl_or_b32 v4, v2, 3, v4
    v_bfe_u32 v2, v3, 3, 1
    v_lshl_or_b32 v4, v2, 2, v4
    s_movk_i32 s49, 3840
    v_mad_u32_u24 v13, v4, s49, v5

    s_add_u32 m0, s56, 30720
    s_nop 0
    buffer_load_dwordx4 v13, s[28:31], s46 offen lds
    v_add_u32 v2, 1536, v30
    v_mul_u32_u24 v3, 2185, v2
    v_lshrrev_b32 v3, 16, v3
    v_mul_u32_u24 v31, 30, v3
    v_sub_u32 v4, v2, v31
    v_mul_u32_u24 v5, 13, v4
    v_lshrrev_b32 v5, 7, v5
    v_mul_u32_u24 v31, 10, v5
    v_sub_u32 v4, v4, v31
    v_mul_u32_u24 v5, 1280, v5
    v_lshl_add_u32 v5, v4, 4, v5
    v_and_b32 v4, 0x33, v3
    v_bfe_u32 v2, v3, 2, 1
    v_lshl_or_b32 v4, v2, 3, v4
    v_bfe_u32 v2, v3, 3, 1
    v_lshl_or_b32 v4, v2, 2, v4
    s_movk_i32 s49, 3840
    v_mad_u32_u24 v14, v4, s49, v5

    s_add_u32 m0, s56, 34816
    s_nop 0
    buffer_load_dwordx4 v14, s[28:31], s46 offen lds
    v_add_u32 v2, 1664, v30
    v_mul_u32_u24 v3, 2185, v2
    v_lshrrev_b32 v3, 16, v3
    v_mul_u32_u24 v31, 30, v3
    v_sub_u32 v4, v2, v31
    v_mul_u32_u24 v5, 13, v4
    v_lshrrev_b32 v5, 7, v5
    v_mul_u32_u24 v31, 10, v5
    v_sub_u32 v4, v4, v31
    v_mul_u32_u24 v5, 1280, v5
    v_lshl_add_u32 v5, v4, 4, v5
    v_and_b32 v4, 0x33, v3
    v_bfe_u32 v2, v3, 2, 1
    v_lshl_or_b32 v4, v2, 3, v4
    v_bfe_u32 v2, v3, 3, 1
    v_lshl_or_b32 v4, v2, 2, v4
    s_movk_i32 s49, 3840
    v_mad_u32_u24 v15, v4, s49, v5

    s_cmp_lt_u32 s44, 2
    s_cbranch_scc0 L_a_w1
    s_add_u32 m0, s56, 8192
    s_add_u32 s57, s54, 81920
    s_add_u32 s57, s57, s45
    buffer_load_dwordx4 v16, s[24:27], s57 offen lds
    s_branch L_a_e1
L_a_w1:
    s_add_u32 m0, s56, 36864
    s_nop 0
    buffer_load_dwordx4 v15, s[28:31], s46 offen lds
L_a_e1:
    s_add_u32 s45, s45, 128
    s_add_u32 s46, s46, 245760
    s_cmp_ge_u32 s45, 1280
    s_cselect_b32 s66, 1280, 0
    s_cselect_b32 s67, 2457600, 0
    s_sub_u32 s45, s45, s66
    s_sub_u32 s46, s46, s67
    s_add_u32 m0, s56, 40960
    s_add_u32 s57, s55, s45
    s_mov_b64 exec, s[68:69]
    buffer_load_dwordx4 v16, s[24:27], s57 offen lds
    s_mov_b64 exec, -1
    s_add_u32 m0, s56, 51200
    s_nop 0
    buffer_load_dwordx4 v8, s[28:31], s46 offen lds
    s_add_u32 m0, s56, 55296
    s_nop 0
    buffer_load_dwordx4 v9, s[28:31], s46 offen lds
    s_add_u32 m0, s56, 59392
    s_nop 0
    buffer_load_dwordx4 v10, s[28:31], s46 offen lds
    s_add_u32 m0, s56, 63488
    s_nop 0
    buffer_load_dwordx4 v11, s[28:31], s46 offen lds
    s_add_u32 m0, s56, 45056
    s_add_u32 s57, s54, 40960
    s_add_u32 s57, s57, s45
    buffer_load_dwordx4 v16, s[24:27], s57 offen lds
    s_add_u32 m0, s56, 67584
    s_nop 0
    buffer_load_dwordx4 v12, s[28:31], s46 offen lds
    s_add_u32 m0, s56, 71680
    s_nop 0
    buffer_load_dwordx4 v13, s[28:31], s46 offen lds
    s_add_u32 m0, s56, 75776
    s_nop 0
    buffer_load_dwordx4 v14, s[28:31], s46 offen lds
    s_cmp_lt_u32 s44, 2
    s_cbranch_scc0 L_a_w2
    s_add_u32 m0, s56, 49152
    s_add_u32 s57, s54, 81920
    s_add_u32 s57, s57, s45
    buffer_load_dwordx4 v16, s[24:27], s57 offen lds
    s_branch L_a_e2
L_a_w2:
    s_add_u32 m0, s56, 77824
    s_nop 0
    buffer_load_dwordx4 v15, s[28:31], s46 offen lds
L_a_e2:
    s_add_u32 s45, s45, 128
    s_add_u32 s46, s46, 245760
    s_cmp_ge_u32 s45, 1280
    s_cselect_b32 s66, 1280, 0
    s_cselect_b32 s67, 2457600, 0
    s_sub_u32 s45, s45, s66
    s_sub_u32 s46, s46, s67
    s_add_u32 s32, s8, 0x960000
    s_addc_u32 s33, s9, 0
    s_mov_b32 s34, 0x30000
    s_mov_b32 s35, 0x00020000
    v_mov_b32 v32, -1
    v_mov_b32 v33, -1
    v_mov_b32 v34, 0
    s_lshr_b32 s49, s51, 3
    s_lshl_b32 s58, s50, 2
    s_add_u32 s49, s49, s58
    s_lshl_b32 s49, s49, 2
    s_add_u32 s49, s49, s44
    s_lshl_b32 s49, s49, 10
    s_and_b32 s58, s51, 7
    s_lshl_b32 s58, s58, 7
    s_add_u32 s49, s49, s58
    s_lshl_b32 s58, s2, 8
    s_add_u32 s58, s58, 0x20000
    v_lshlrev_b32 v2, 3, v1
    s_mov_b64 exec, 0xffff

    buffer_store_dwordx2 v[32:33], v2, s[32:35], s49 offen sc1
    s_mov_b64 exec, 1
    buffer_store_dword v34, v2, s[32:35], s58 offen sc1
    s_mov_b64 exec, -1
    s_mov_b32 s36, s10
    s_mov_b32 s37, s11
    s_mov_b32 s38, 0xc8000
    s_mov_b32 s39, 0x00020000
    s_mul_i32 s49, s51, 25600
    v_lshlrev_b32 v2, 7, v0
    v_cmp_gt_u32 vcc, 200, v0
    v_mov_b32 v3, 0x7ff00000
    s_nop 0
    v_cndmask_b32 v2, v3, v2, vcc
    buffer_load_dword v60, v2, s[36:39], s49 offen
    v_lshlrev_b32 v2, 4, v0
    v_mov_b32 v36, 0x3f803f80
    v_mov_b32 v37, 0x3f803f80
    v_mov_b32 v38, 0x3f803f80
    v_mov_b32 v39, 0x3f803f80
    v_add_u32 v3, 81920, v2
    v_cmp_gt_u32 vcc, 8, v0
    s_and_saveexec_b64 s[62:63], vcc
    ds_write_b128 v2, v[36:39]
    ds_write_b128 v2, v[36:39] offset:40960
    ds_write_b128 v3, v[36:39]
    s_mov_b64 exec, s[62:63]
    v_lshrrev_b32 v2, 3, v7
    v_lshlrev_b32 v2, 10, v2
    v_and_b32 v3, 7, v7
    v_lshl_add_u32 v2, v3, 7, v2
    v_lshrrev_b32 v3, 1, v7
    v_xor_b32 v3, v3, v6
    v_lshl_add_u32 v17, v3, 4, v2
    v_xor_b32 v3, 4, v3
    v_lshl_add_u32 v18, v3, 4, v2
    v_lshrrev_b32 v2, 1, v6
    v_lshlrev_b32 v2, 4, v2
    v_and_b32 v3, 1, v6
    v_lshl_add_u32 v2, v3, 2, v2
    v_bfe_u32 v3, v1, 2, 2
    v_add_u32 v2, v2, v3
    v_mul_u32_u24 v2, 480, v2
    v_and_b32 v3, 3, v1
    v_lshl_add_u32 v2, v3, 3, v2
    s_lshl_b32 s49, s44, 7
    s_add_u32 s49, s49, 10240
    v_add_u32 v23, s49, v2

    v_add_u32 v19, 40960, v17
    v_add_u32 v20, 40960, v18
    v_add_u32 v24, 40960, v23

    v_add_u32 v21, 81920, v17
    v_add_u32 v22, 81920, v18
    v_add_u32 v25, 81920, v23

    v_mov_b32 v64, 0
    v_mov_b32 v65, 0
    v_mov_b32 v66, 0
    v_mov_b32 v67, 0
    v_mov_b32 v68, 0
    v_mov_b32 v69, 0
    v_mov_b32 v70, 0
    v_mov_b32 v71, 0
    v_mov_b32 v72, 0
    v_mov_b32 v73, 0
    v_mov_b32 v74, 0
    v_mov_b32 v75, 0
    v_mov_b32 v76, 0
    v_mov_b32 v77, 0
    v_mov_b32 v78, 0
    v_mov_b32 v79, 0
    v_mov_b32 v80, 0
    v_mov_b32 v81, 0
    v_mov_b32 v82, 0
    v_mov_b32 v83, 0
    v_mov_b32 v84, 0
    v_mov_b32 v85, 0
    v_mov_b32 v86, 0
    v_mov_b32 v87, 0
    v_mov_b32 v88, 0
    v_mov_b32 v89, 0
    v_mov_b32 v90, 0
    v_mov_b32 v91, 0
    v_mov_b32 v92, 0
    v_mov_b32 v93, 0
    v_mov_b32 v94, 0
    v_mov_b32 v95, 0
    v_mov_b32 v96, 0
    v_mov_b32 v97, 0
    v_mov_b32 v98, 0
    v_mov_b32 v99, 0
    v_mov_b32 v100, 0
    v_mov_b32 v101, 0
    v_mov_b32 v102, 0
    v_mov_b32 v103, 0
    v_mov_b32 v104, 0
    v_mov_b32 v105, 0
    v_mov_b32 v106, 0
    v_mov_b32 v107, 0
    v_mov_b32 v108, 0
    v_mov_b32 v109, 0
    v_mov_b32 v110, 0
    v_mov_b32 v111, 0
    v_mov_b32 v112, 0
    v_mov_b32 v113, 0
    v_mov_b32 v114, 0
    v_mov_b32 v115, 0
    v_mov_b32 v116, 0
    v_mov_b32 v117, 0
    v_mov_b32 v118, 0
    v_mov_b32 v119, 0
    v_mov_b32 v120, 0
    v_mov_b32 v121, 0
    v_mov_b32 v122, 0
    v_mov_b32 v123, 0
    v_mov_b32 v124, 0
    v_mov_b32 v125, 0
    v_mov_b32 v126, 0
    v_mov_b32 v127, 0
    v_mov_b32 v128, 0
    v_mov_b32 v129, 0
    v_mov_b32 v130, 0
    v_mov_b32 v131, 0
    v_mov_b32 v132, 0
    v_mov_b32 v133, 0
    v_mov_b32 v134, 0
    v_mov_b32 v135, 0
    v_mov_b32 v136, 0
    v_mov_b32 v137, 0
    v_mov_b32 v138, 0
    v_mov_b32 v139, 0
    v_mov_b32 v140, 0
    v_mov_b32 v141, 0
    v_mov_b32 v142, 0
    v_mov_b32 v143, 0
    v_mov_b32 v216, 0
    v_mov_b32 v217, 0
    v_mov_b32 v218, 0
    v_mov_b32 v219, 0
    v_mov_b32 v220, 0
    v_mov_b32 v221, 0
    v_mov_b32 v222, 0
    v_mov_b32 v223, 0
    v_mov_b32 v224, 0
    v_mov_b32 v225, 0
    v_mov_b32 v226, 0
    v_mov_b32 v227, 0
    v_mov_b32 v228, 0
    v_mov_b32 v229, 0
    v_mov_b32 v230, 0
    v_mov_b32 v231, 0
    v_mov_b32 v232, 0
    v_mov_b32 v233, 0
    v_mov_b32 v234, 0
    v_mov_b32 v235, 0
    v_mov_b32 v236, 0
    v_mov_b32 v237, 0
    v_mov_b32 v238, 0
    v_mov_b32 v239, 0
    v_mov_b32 v240, 0
    v_mov_b32 v241, 0
    v_mov_b32 v242, 0
    v_mov_b32 v243, 0
    v_mov_b32 v244, 0
    v_mov_b32 v245, 0
    v_mov_b32 v246, 0
    v_mov_b32 v247, 0
    v_mov_b32 v248, 0
    v_mov_b32 v249, 0
    v_mov_b32 v250, 0
    v_mov_b32 v251, 0
    v_mov_b32 v252, 0
    v_mov_b32 v253, 0
    v_mov_b32 v254, 0
    v_mov_b32 v255, 0
    s_add_u32 m0, s56, 81920
    s_add_u32 s57, s55, s45
    s_mov_b64 exec, s[68:69]
    buffer_load_dwordx4 v16, s[24:27], s57 offen lds
    s_mov_b64 exec, -1
    s_add_u32 m0, s56, 92160
    s_nop 0
    buffer_load_dwordx4 v8, s[28:31], s46 offen lds
    s_add_u32 m0, s56, 96256
    s_nop 0
    buffer_load_dwordx4 v9, s[28:31], s46 offen lds
    s_add_u32 m0, s56, 100352
    s_nop 0
    buffer_load_dwordx4 v10, s[28:31], s46 offen lds
    s_add_u32 m0, s56, 104448
    s_nop 0
    buffer_load_dwordx4 v11, s[28:31], s46 offen lds
    s_add_u32 m0, s56, 86016
    s_add_u32 s57, s54, 40960
    s_add_u32 s57, s57, s45
    buffer_load_dwordx4 v16, s[24:27], s57 offen lds
    s_add_u32 m0, s56, 108544
    s_nop 0
    buffer_load_dwordx4 v12, s[28:31], s46 offen lds
    s_add_u32 m0, s56, 112640
    s_nop 0
    buffer_load_dwordx4 v13, s[28:31], s46 offen lds
    s_add_u32 m0, s56, 116736
    s_nop 0
    buffer_load_dwordx4 v14, s[28:31], s46 offen lds
    s_cmp_lt_u32 s44, 2
    s_cbranch_scc0 L_a_w3
    s_add_u32 m0, s56, 90112
    s_add_u32 s57, s54, 81920
    s_add_u32 s57, s57, s45
    buffer_load_dwordx4 v16, s[24:27], s57 offen lds
    s_branch L_a_e3
L_a_w3:
    s_add_u32 m0, s56, 118784
    s_nop 0
    buffer_load_dwordx4 v15, s[28:31], s46 offen lds
L_a_e3:
    s_add_u32 s45, s45, 128
    s_add_u32 s46, s46, 245760
    s_cmp_ge_u32 s45, 1280
    s_cselect_b32 s66, 1280, 0
    s_cselect_b32 s67, 2457600, 0
    s_sub_u32 s45, s45, s66
    s_sub_u32 s46, s46, s67
    s_waitcnt vmcnt(23)
    s_waitcnt lgkmcnt(0)
    s_barrier
    ds_read_b64_tr_b16 v[144:145], v23 offset:0
    ds_read_b64_tr_b16 v[146:147], v23 offset:3840
    ds_read_b64_tr_b16 v[148:149], v23 offset:32
    ds_read_b64_tr_b16 v[150:151], v23 offset:3872
    ds_read_b64_tr_b16 v[152:153], v23 offset:64
    ds_read_b64_tr_b16 v[154:155], v23 offset:3904
    ds_read_b64_tr_b16 v[156:157], v23 offset:96
    ds_read_b64_tr_b16 v[158:159], v23 offset:3936
    ds_read_b128 v[176:179], v17 offset:0
    ds_read_b128 v[180:183], v17 offset:2048
    ds_read_b128 v[184:187], v17 offset:4096
    ds_read_b128 v[188:191], v17 offset:6144
    ds_read_b128 v[192:195], v17 offset:8192
    s_waitcnt lgkmcnt(0)
    v_mfma_f32_16x16x32_bf16 v[64:67], v[144:147], v[176:179], v[64:67]
    ds_read_b64_tr_b16 v[160:161], v23 offset:15360
    ds_read_b64_tr_b16 v[162:163], v23 offset:19200
    v_mfma_f32_16x16x32_bf16 v[68:71], v[144:147], v[180:183], v[68:71]
    ds_read_b64_tr_b16 v[164:165], v23 offset:15392
    ds_read_b64_tr_b16 v[166:167], v23 offset:19232
    v_mfma_f32_16x16x32_bf16 v[72:75], v[144:147], v[184:187], v[72:75]
    ds_read_b64_tr_b16 v[168:169], v23 offset:15424
    ds_read_b64_tr_b16 v[170:171], v23 offset:19264
    v_mfma_f32_16x16x32_bf16 v[76:79], v[144:147], v[188:191], v[76:79]
    ds_read_b64_tr_b16 v[172:173], v23 offset:15456
    ds_read_b64_tr_b16 v[174:175], v23 offset:19296
    v_mfma_f32_16x16x32_bf16 v[80:83], v[144:147], v[192:195], v[80:83]
    ds_read_b128 v[196:199], v18 offset:0
    ds_read_b128 v[200:203], v18 offset:2048
    v_mfma_f32_16x16x32_bf16 v[84:87], v[148:151], v[176:179], v[84:87]
    ds_read_b128 v[204:207], v18 offset:4096
    ds_read_b128 v[208:211], v18 offset:6144
    v_mfma_f32_16x16x32_bf16 v[88:91], v[148:151], v[180:183], v[88:91]
    ds_read_b128 v[212:215], v18 offset:8192
    v_mfma_f32_16x16x32_bf16 v[92:95], v[148:151], v[184:187], v[92:95]
    v_mfma_f32_16x16x32_bf16 v[96:99], v[148:151], v[188:191], v[96:99]
    v_mfma_f32_16x16x32_bf16 v[100:103], v[148:151], v[192:195], v[100:103]
    v_mfma_f32_16x16x32_bf16 v[104:107], v[152:155], v[176:179], v[104:107]
    v_mfma_f32_16x16x32_bf16 v[108:111], v[152:155], v[180:183], v[108:111]
    v_mfma_f32_16x16x32_bf16 v[112:115], v[152:155], v[184:187], v[112:115]
    v_mfma_f32_16x16x32_bf16 v[116:119], v[152:155], v[188:191], v[116:119]
    v_mfma_f32_16x16x32_bf16 v[120:123], v[152:155], v[192:195], v[120:123]
    v_mfma_f32_16x16x32_bf16 v[124:127], v[156:159], v[176:179], v[124:127]
    v_mfma_f32_16x16x32_bf16 v[128:131], v[156:159], v[180:183], v[128:131]
    v_mfma_f32_16x16x32_bf16 v[132:135], v[156:159], v[184:187], v[132:135]
    v_mfma_f32_16x16x32_bf16 v[136:139], v[156:159], v[188:191], v[136:139]
    v_mfma_f32_16x16x32_bf16 v[140:143], v[156:159], v[192:195], v[140:143]
    s_cmp_lg_u32 s44, 0
    s_cbranch_scc1 L_a_ns0
    v_mfma_f32_16x16x32_bf16 v[216:219], v[36:39], v[176:179], v[216:219]
    v_mfma_f32_16x16x32_bf16 v[220:223], v[176:179], v[176:179], v[220:223]
    v_mfma_f32_16x16x32_bf16 v[224:227], v[36:39], v[180:183], v[224:227]
    v_mfma_f32_16x16x32_bf16 v[228:231], v[180:183], v[180:183], v[228:231]
    v_mfma_f32_16x16x32_bf16 v[232:235], v[36:39], v[184:187], v[232:235]
    v_mfma_f32_16x16x32_bf16 v[236:239], v[184:187], v[184:187], v[236:239]
    v_mfma_f32_16x16x32_bf16 v[240:243], v[36:39], v[188:191], v[240:243]
    v_mfma_f32_16x16x32_bf16 v[244:247], v[188:191], v[188:191], v[244:247]
    v_mfma_f32_16x16x32_bf16 v[248:251], v[36:39], v[192:195], v[248:251]
    v_mfma_f32_16x16x32_bf16 v[252:255], v[192:195], v[192:195], v[252:255]
L_a_ns0:
    s_waitcnt lgkmcnt(0)
    v_mfma_f32_16x16x32_bf16 v[64:67], v[160:163], v[196:199], v[64:67]
    v_mfma_f32_16x16x32_bf16 v[68:71], v[160:163], v[200:203], v[68:71]
    v_mfma_f32_16x16x32_bf16 v[72:75], v[160:163], v[204:207], v[72:75]
    v_mfma_f32_16x16x32_bf16 v[76:79], v[160:163], v[208:211], v[76:79]
    v_mfma_f32_16x16x32_bf16 v[80:83], v[160:163], v[212:215], v[80:83]
    v_mfma_f32_16x16x32_bf16 v[84:87], v[164:167], v[196:199], v[84:87]
    s_waitcnt vmcnt(13)
    s_barrier
    ds_read_b64_tr_b16 v[144:145], v24 offset:0
    ds_read_b64_tr_b16 v[146:147], v24 offset:3840
    ds_read_b64_tr_b16 v[148:149], v24 offset:32
    ds_read_b64_tr_b16 v[150:151], v24 offset:3872
    ds_read_b64_tr_b16 v[152:153], v24 offset:64
    ds_read_b64_tr_b16 v[154:155], v24 offset:3904
    ds_read_b64_tr_b16 v[156:157], v24 offset:96
    ds_read_b64_tr_b16 v[158:159], v24 offset:3936
    ds_read_b128 v[176:179], v19 offset:0
    ds_read_b128 v[180:183], v19 offset:2048
    ds_read_b128 v[184:187], v19 offset:4096
    ds_read_b128 v[188:191], v19 offset:6144
    ds_read_b128 v[192:195], v19 offset:8192
    v_mfma_f32_16x16x32_bf16 v[88:91], v[164:167], v[200:203], v[88:91]
    v_mfma_f32_16x16x32_bf16 v[92:95], v[164:167], v[204:207], v[92:95]
    v_mfma_f32_16x16x32_bf16 v[96:99], v[164:167], v[208:211], v[96:99]
    s_add_u32 m0, s56, 0
    s_add_u32 s57, s55, s45
    s_mov_b64 exec, s[68:69]
    buffer_load_dwordx4 v16, s[24:27], s57 offen lds
    s_mov_b64 exec, -1
    v_mfma_f32_16x16x32_bf16 v[100:103], v[164:167], v[212:215], v[100:103]
    v_mfma_f32_16x16x32_bf16 v[104:107], v[168:171], v[196:199], v[104:107]
    v_mfma_f32_16x16x32_bf16 v[108:111], v[168:171], v[200:203], v[108:111]
    s_add_u32 m0, s56, 10240
    s_nop 0
    buffer_load_dwordx4 v8, s[28:31], s46 offen lds
    v_mfma_f32_16x16x32_bf16 v[112:115], v[168:171], v[204:207], v[112:115]
    v_mfma_f32_16x16x32_bf16 v[116:119], v[168:171], v[208:211], v[116:119]
    v_mfma_f32_16x16x32_bf16 v[120:123], v[168:171], v[212:215], v[120:123]
    s_add_u32 m0, s56, 14336
    s_nop 0
    buffer_load_dwordx4 v9, s[28:31], s46 offen lds
    v_mfma_f32_16x16x32_bf16 v[124:127], v[172:175], v[196:199], v[124:127]
    v_mfma_f32_16x16x32_bf16 v[128:131], v[172:175], v[200:203], v[128:131]
    s_add_u32 m0, s56, 18432
    s_nop 0
    buffer_load_dwordx4 v10, s[28:31], s46 offen lds
    v_mfma_f32_16x16x32_bf16 v[132:135], v[172:175], v[204:207], v[132:135]
    v_mfma_f32_16x16x32_bf16 v[136:139], v[172:175], v[208:211], v[136:139]
    s_add_u32 m0, s56, 22528
    s_nop 0
    buffer_load_dwordx4 v11, s[28:31], s46 offen lds
    v_mfma_f32_16x16x32_bf16 v[140:143], v[172:175], v[212:215], v[140:143]
    s_cmp_lg_u32 s44, 1
    s_cbranch_scc1 L_a_ns1
    v_mfma_f32_16x16x32_bf16 v[216:219], v[36:39], v[196:199], v[216:219]
    v_mfma_f32_16x16x32_bf16 v[220:223], v[196:199], v[196:199], v[220:223]
    v_mfma_f32_16x16x32_bf16 v[224:227], v[36:39], v[200:203], v[224:227]
    v_mfma_f32_16x16x32_bf16 v[228:231], v[200:203], v[200:203], v[228:231]
    v_mfma_f32_16x16x32_bf16 v[232:235], v[36:39], v[204:207], v[232:235]
    v_mfma_f32_16x16x32_bf16 v[236:239], v[204:207], v[204:207], v[236:239]
    v_mfma_f32_16x16x32_bf16 v[240:243], v[36:39], v[208:211], v[240:243]
    v_mfma_f32_16x16x32_bf16 v[244:247], v[208:211], v[208:211], v[244:247]
    v_mfma_f32_16x16x32_bf16 v[248:251], v[36:39], v[212:215], v[248:251]
    v_mfma_f32_16x16x32_bf16 v[252:255], v[212:215], v[212:215], v[252:255]
L_a_ns1:
    s_waitcnt lgkmcnt(0)
    v_mfma_f32_16x16x32_bf16 v[64:67], v[144:147], v[176:179], v[64:67]
    ds_read_b64_tr_b16 v[160:161], v24 offset:15360
    ds_read_b64_tr_b16 v[162:163], v24 offset:19200
    v_mfma_f32_16x16x32_bf16 v[68:71], v[144:147], v[180:183], v[68:71]
    ds_read_b64_tr_b16 v[164:165], v24 offset:15392
    ds_read_b64_tr_b16 v[166:167], v24 offset:19232
    v_mfma_f32_16x16x32_bf16 v[72:75], v[144:147], v[184:187], v[72:75]
    ds_read_b64_tr_b16 v[168:169], v24 offset:15424
    ds_read_b64_tr_b16 v[170:171], v24 offset:19264
    s_add_u32 m0, s56, 4096
    s_add_u32 s57, s54, 40960
    s_add_u32 s57, s57, s45
    buffer_load_dwordx4 v16, s[24:27], s57 offen lds
    v_mfma_f32_16x16x32_bf16 v[76:79], v[144:147], v[188:191], v[76:79]
    ds_read_b64_tr_b16 v[172:173], v24 offset:15456
    ds_read_b64_tr_b16 v[174:175], v24 offset:19296
    v_mfma_f32_16x16x32_bf16 v[80:83], v[144:147], v[192:195], v[80:83]
    ds_read_b128 v[196:199], v20 offset:0
    ds_read_b128 v[200:203], v20 offset:2048
    v_mfma_f32_16x16x32_bf16 v[84:87], v[148:151], v[176:179], v[84:87]
    ds_read_b128 v[204:207], v20 offset:4096
    ds_read_b128 v[208:211], v20 offset:6144
    v_mfma_f32_16x16x32_bf16 v[88:91], v[148:151], v[180:183], v[88:91]
    ds_read_b128 v[212:215], v20 offset:8192
    s_add_u32 m0, s56, 26624
    s_nop 0
    buffer_load_dwordx4 v12, s[28:31], s46 offen lds
    v_mfma_f32_16x16x32_bf16 v[92:95], v[148:151], v[184:187], v[92:95]
    v_mfma_f32_16x16x32_bf16 v[96:99], v[148:151], v[188:191], v[96:99]
    v_mfma_f32_16x16x32_bf16 v[100:103], v[148:151], v[192:195], v[100:103]
    v_mfma_f32_16x16x32_bf16 v[104:107], v[152:155], v[176:179], v[104:107]
    s_add_u32 m0, s56, 30720
    s_nop 0
    buffer_load_dwordx4 v13, s[28:31], s46 offen lds
    v_mfma_f32_16x16x32_bf16 v[108:111], v[152:155], v[180:183], v[108:111]
    v_mfma_f32_16x16x32_bf16 v[112:115], v[152:155], v[184:187], v[112:115]
    v_mfma_f32_16x16x32_bf16 v[116:119], v[152:155], v[188:191], v[116:119]
    v_mfma_f32_16x16x32_bf16 v[120:123], v[152:155], v[192:195], v[120:123]
    s_add_u32 m0, s56, 34816
    s_nop 0
    buffer_load_dwordx4 v14, s[28:31], s46 offen lds
    v_mfma_f32_16x16x32_bf16 v[124:127], v[156:159], v[176:179], v[124:127]
    v_mfma_f32_16x16x32_bf16 v[128:131], v[156:159], v[180:183], v[128:131]
    v_mfma_f32_16x16x32_bf16 v[132:135], v[156:159], v[184:187], v[132:135]
    v_mfma_f32_16x16x32_bf16 v[136:139], v[156:159], v[188:191], v[136:139]
    s_cmp_lt_u32 s44, 2
    s_cbranch_scc0 L_a_w4
    s_add_u32 m0, s56, 8192
    s_add_u32 s57, s54, 81920
    s_add_u32 s57, s57, s45
    buffer_load_dwordx4 v16, s[24:27], s57 offen lds
    s_branch L_a_e4
L_a_w4:
    s_add_u32 m0, s56, 36864
    s_nop 0
    buffer_load_dwordx4 v15, s[28:31], s46 offen lds
L_a_e4:
    s_add_u32 s45, s45, 128
    s_add_u32 s46, s46, 245760
    s_cmp_ge_u32 s45, 1280
    s_cselect_b32 s66, 1280, 0
    s_cselect_b32 s67, 2457600, 0
    s_sub_u32 s45, s45, s66
    s_sub_u32 s46, s46, s67
    v_mfma_f32_16x16x32_bf16 v[140:143], v[156:159], v[192:195], v[140:143]
    s_cmp_lg_u32 s44, 2
    s_cbranch_scc1 L_a_ns2
    v_mfma_f32_16x16x32_bf16 v[216:219], v[36:39], v[176:179], v[216:219]
    v_mfma_f32_16x16x32_bf16 v[220:223], v[176:179], v[176:179], v[220:223]
    v_mfma_f32_16x16x32_bf16 v[224:227], v[36:39], v[180:183], v[224:227]
    v_mfma_f32_16x16x32_bf16 v[228:231], v[180:183], v[180:183], v[228:231]
    v_mfma_f32_16x16x32_bf16 v[232:235], v[36:39], v[184:187], v[232:235]
    v_mfma_f32_16x16x32_bf16 v[236:239], v[184:187], v[184:187], v[236:239]
    v_mfma_f32_16x16x32_bf16 v[240:243], v[36:39], v[188:191], v[240:243]
    v_mfma_f32_16x16x32_bf16 v[244:247], v[188:191], v[188:191], v[244:247]
    v_mfma_f32_16x16x32_bf16 v[248:251], v[36:39], v[192:195], v[248:251]
    v_mfma_f32_16x16x32_bf16 v[252:255], v[192:195], v[192:195], v[252:255]
L_a_ns2:
    s_waitcnt lgkmcnt(0)
    v_mfma_f32_16x16x32_bf16 v[64:67], v[160:163], v[196:199], v[64:67]
    v_mfma_f32_16x16x32_bf16 v[68:71], v[160:163], v[200:203], v[68:71]
    v_mfma_f32_16x16x32_bf16 v[72:75], v[160:163], v[204:207], v[72:75]
    v_mfma_f32_16x16x32_bf16 v[76:79], v[160:163], v[208:211], v[76:79]
    v_mfma_f32_16x16x32_bf16 v[80:83], v[160:163], v[212:215], v[80:83]
    v_mfma_f32_16x16x32_bf16 v[84:87], v[164:167], v[196:199], v[84:87]
    s_waitcnt vmcnt(10)
    s_barrier
    ds_read_b64_tr_b16 v[144:145], v25 offset:0
    ds_read_b64_tr_b16 v[146:147], v25 offset:3840
    ds_read_b64_tr_b16 v[148:149], v25 offset:32
    ds_read_b64_tr_b16 v[150:151], v25 offset:3872
    ds_read_b64_tr_b16 v[152:153], v25 offset:64
    ds_read_b64_tr_b16 v[154:155], v25 offset:3904
    ds_read_b64_tr_b16 v[156:157], v25 offset:96
    ds_read_b64_tr_b16 v[158:159], v25 offset:3936
    ds_read_b128 v[176:179], v21 offset:0
    ds_read_b128 v[180:183], v21 offset:2048
    ds_read_b128 v[184:187], v21 offset:4096
    ds_read_b128 v[188:191], v21 offset:6144
    ds_read_b128 v[192:195], v21 offset:8192
    s_mov_b32 s32, s22
    s_mov_b32 s33, s23
    s_mov_b32 s34, 0x100
    s_mov_b32 s35, 0x00020000
    v_mov_b32 v2, 0
    v_mov_b32 v3, 1
    v_cmp_eq_u32 vcc, 0, v0
    s_and_saveexec_b64 s[62:63], vcc
    s_cbranch_execz L_a_cnt
    buffer_atomic_add v3, v2, s[32:35], 0 offen sc1

L_a_cnt:
    s_mov_b64 exec, s[62:63]
    v_mfma_f32_16x16x32_bf16 v[88:91], v[164:167], v[200:203], v[88:91]
    v_mfma_f32_16x16x32_bf16 v[92:95], v[164:167], v[204:207], v[92:95]
    v_mfma_f32_16x16x32_bf16 v[96:99], v[164:167], v[208:211], v[96:99]
    s_add_u32 m0, s56, 40960
    s_add_u32 s57, s55, s45
    s_mov_b64 exec, s[68:69]
    buffer_load_dwordx4 v16, s[24:27], s57 offen lds
    s_mov_b64 exec, -1
    v_mfma_f32_16x16x32_bf16 v[100:103], v[164:167], v[212:215], v[100:103]
    v_mfma_f32_16x16x32_bf16 v[104:107], v[168:171], v[196:199], v[104:107]
    v_mfma_f32_16x16x32_bf16 v[108:111], v[168:171], v[200:203], v[108:111]
    s_add_u32 m0, s56, 51200
    s_nop 0
    buffer_load_dwordx4 v8, s[28:31], s46 offen lds
    v_mfma_f32_16x16x32_bf16 v[112:115], v[168:171], v[204:207], v[112:115]
    v_mfma_f32_16x16x32_bf16 v[116:119], v[168:171], v[208:211], v[116:119]
    v_mfma_f32_16x16x32_bf16 v[120:123], v[168:171], v[212:215], v[120:123]
    s_add_u32 m0, s56, 55296
    s_nop 0
    buffer_load_dwordx4 v9, s[28:31], s46 offen lds
    v_mfma_f32_16x16x32_bf16 v[124:127], v[172:175], v[196:199], v[124:127]
    v_mfma_f32_16x16x32_bf16 v[128:131], v[172:175], v[200:203], v[128:131]
    s_add_u32 m0, s56, 59392
    s_nop 0
    buffer_load_dwordx4 v10, s[28:31], s46 offen lds
    v_mfma_f32_16x16x32_bf16 v[132:135], v[172:175], v[204:207], v[132:135]
    v_mfma_f32_16x16x32_bf16 v[136:139], v[172:175], v[208:211], v[136:139]
    s_add_u32 m0, s56, 63488
    s_nop 0
    buffer_load_dwordx4 v11, s[28:31], s46 offen lds
    v_mfma_f32_16x16x32_bf16 v[140:143], v[172:175], v[212:215], v[140:143]
    s_cmp_lg_u32 s44, 3
    s_cbranch_scc1 L_a_ns3
    v_mfma_f32_16x16x32_bf16 v[216:219], v[36:39], v[196:199], v[216:219]
    v_mfma_f32_16x16x32_bf16 v[220:223], v[196:199], v[196:199], v[220:223]
    v_mfma_f32_16x16x32_bf16 v[224:227], v[36:39], v[200:203], v[224:227]
    v_mfma_f32_16x16x32_bf16 v[228:231], v[200:203], v[200:203], v[228:231]
    v_mfma_f32_16x16x32_bf16 v[232:235], v[36:39], v[204:207], v[232:235]
    v_mfma_f32_16x16x32_bf16 v[236:239], v[204:207], v[204:207], v[236:239]
    v_mfma_f32_16x16x32_bf16 v[240:243], v[36:39], v[208:211], v[240:243]
    v_mfma_f32_16x16x32_bf16 v[244:247], v[208:211], v[208:211], v[244:247]
    v_mfma_f32_16x16x32_bf16 v[248:251], v[36:39], v[212:215], v[248:251]
    v_mfma_f32_16x16x32_bf16 v[252:255], v[212:215], v[212:215], v[252:255]
L_a_ns3:
    s_waitcnt lgkmcnt(0)
    v_mfma_f32_16x16x32_bf16 v[64:67], v[144:147], v[176:179], v[64:67]
    ds_read_b64_tr_b16 v[160:161], v25 offset:15360
    ds_read_b64_tr_b16 v[162:163], v25 offset:19200
    v_mfma_f32_16x16x32_bf16 v[68:71], v[144:147], v[180:183], v[68:71]
    ds_read_b64_tr_b16 v[164:165], v25 offset:15392
    ds_read_b64_tr_b16 v[166:167], v25 offset:19232
    v_mfma_f32_16x16x32_bf16 v[72:75], v[144:147], v[184:187], v[72:75]
    ds_read_b64_tr_b16 v[168:169], v25 offset:15424
    ds_read_b64_tr_b16 v[170:171], v25 offset:19264
    s_add_u32 m0, s56, 45056
    s_add_u32 s57, s54, 40960
    s_add_u32 s57, s57, s45
    buffer_load_dwordx4 v16, s[24:27], s57 offen lds
    v_mfma_f32_16x16x32_bf16 v[76:79], v[144:147], v[188:191], v[76:79]
    ds_read_b64_tr_b16 v[172:173], v25 offset:15456
    ds_read_b64_tr_b16 v[174:175], v25 offset:19296
    v_mfma_f32_16x16x32_bf16 v[80:83], v[144:147], v[192:195], v[80:83]
    ds_read_b128 v[196:199], v22 offset:0
    ds_read_b128 v[200:203], v22 offset:2048
    v_mfma_f32_16x16x32_bf16 v[84:87], v[148:151], v[176:179], v[84:87]
    ds_read_b128 v[204:207], v22 offset:4096
    ds_read_b128 v[208:211], v22 offset:6144
    v_mfma_f32_16x16x32_bf16 v[88:91], v[148:151], v[180:183], v[88:91]
    ds_read_b128 v[212:215], v22 offset:8192
    s_add_u32 m0, s56, 67584
    s_nop 0
    buffer_load_dwordx4 v12, s[28:31], s46 offen lds
    v_mfma_f32_16x16x32_bf16 v[92:95], v[148:151], v[184:187], v[92:95]
    v_mfma_f32_16x16x32_bf16 v[96:99], v[148:151], v[188:191], v[96:99]
    v_mfma_f32_16x16x32_bf16 v[100:103], v[148:151], v[192:195], v[100:103]
    v_mfma_f32_16x16x32_bf16 v[104:107], v[152:155], v[176:179], v[104:107]
    s_add_u32 m0, s56, 71680
    s_nop 0
    buffer_load_dwordx4 v13, s[28:31], s46 offen lds
    v_mfma_f32_16x16x32_bf16 v[108:111], v[152:155], v[180:183], v[108:111]
    v_mfma_f32_16x16x32_bf16 v[112:115], v[152:155], v[184:187], v[112:115]
    v_mfma_f32_16x16x32_bf16 v[116:119], v[152:155], v[188:191], v[116:119]
    v_mfma_f32_16x16x32_bf16 v[120:123], v[152:155], v[192:195], v[120:123]
    s_add_u32 m0, s56, 75776
    s_nop 0
    buffer_load_dwordx4 v14, s[28:31], s46 offen lds
    v_mfma_f32_16x16x32_bf16 v[124:127], v[156:159], v[176:179], v[124:127]
    v_mfma_f32_16x16x32_bf16 v[128:131], v[156:159], v[180:183], v[128:131]
    v_mfma_f32_16x16x32_bf16 v[132:135], v[156:159], v[184:187], v[132:135]
    v_mfma_f32_16x16x32_bf16 v[136:139], v[156:159], v[188:191], v[136:139]
    s_cmp_lt_u32 s44, 2
    s_cbranch_scc0 L_a_w5
    s_add_u32 m0, s56, 49152
    s_add_u32 s57, s54, 81920
    s_add_u32 s57, s57, s45
    buffer_load_dwordx4 v16, s[24:27], s57 offen lds
    s_branch L_a_e5
L_a_w5:
    s_add_u32 m0, s56, 77824
    s_nop 0
    buffer_load_dwordx4 v15, s[28:31], s46 offen lds
L_a_e5:
    s_add_u32 s45, s45, 128
    s_add_u32 s46, s46, 245760
    s_cmp_ge_u32 s45, 1280
    s_cselect_b32 s66, 1280, 0
    s_cselect_b32 s67, 2457600, 0
    s_sub_u32 s45, s45, s66
    s_sub_u32 s46, s46, s67
    v_mfma_f32_16x16x32_bf16 v[140:143], v[156:159], v[192:195], v[140:143]
    s_cmp_lg_u32 s44, 0
    s_cbranch_scc1 L_a_ns4
    v_mfma_f32_16x16x32_bf16 v[216:219], v[36:39], v[176:179], v[216:219]
    v_mfma_f32_16x16x32_bf16 v[220:223], v[176:179], v[176:179], v[220:223]
    v_mfma_f32_16x16x32_bf16 v[224:227], v[36:39], v[180:183], v[224:227]
    v_mfma_f32_16x16x32_bf16 v[228:231], v[180:183], v[180:183], v[228:231]
    v_mfma_f32_16x16x32_bf16 v[232:235], v[36:39], v[184:187], v[232:235]
    v_mfma_f32_16x16x32_bf16 v[236:239], v[184:187], v[184:187], v[236:239]
    v_mfma_f32_16x16x32_bf16 v[240:243], v[36:39], v[188:191], v[240:243]
    v_mfma_f32_16x16x32_bf16 v[244:247], v[188:191], v[188:191], v[244:247]
    v_mfma_f32_16x16x32_bf16 v[248:251], v[36:39], v[192:195], v[248:251]
    v_mfma_f32_16x16x32_bf16 v[252:255], v[192:195], v[192:195], v[252:255]
L_a_ns4:
    s_waitcnt lgkmcnt(0)
    v_mfma_f32_16x16x32_bf16 v[64:67], v[160:163], v[196:199], v[64:67]
    v_mfma_f32_16x16x32_bf16 v[68:71], v[160:163], v[200:203], v[68:71]
    v_mfma_f32_16x16x32_bf16 v[72:75], v[160:163], v[204:207], v[72:75]
    v_mfma_f32_16x16x32_bf16 v[76:79], v[160:163], v[208:211], v[76:79]
    v_mfma_f32_16x16x32_bf16 v[80:83], v[160:163], v[212:215], v[80:83]
    v_mfma_f32_16x16x32_bf16 v[84:87], v[164:167], v[196:199], v[84:87]
    s_waitcnt vmcnt(10)
    s_barrier
    ds_read_b64_tr_b16 v[144:145], v23 offset:0
    ds_read_b64_tr_b16 v[146:147], v23 offset:3840
    ds_read_b64_tr_b16 v[148:149], v23 offset:32
    ds_read_b64_tr_b16 v[150:151], v23 offset:3872
    ds_read_b64_tr_b16 v[152:153], v23 offset:64
    ds_read_b64_tr_b16 v[154:155], v23 offset:3904
    ds_read_b64_tr_b16 v[156:157], v23 offset:96
    ds_read_b64_tr_b16 v[158:159], v23 offset:3936
    ds_read_b128 v[176:179], v17 offset:0
    ds_read_b128 v[180:183], v17 offset:2048
    ds_read_b128 v[184:187], v17 offset:4096
    ds_read_b128 v[188:191], v17 offset:6144
    ds_read_b128 v[192:195], v17 offset:8192
    v_mfma_f32_16x16x32_bf16 v[88:91], v[164:167], v[200:203], v[88:91]
    v_mfma_f32_16x16x32_bf16 v[92:95], v[164:167], v[204:207], v[92:95]
    v_mfma_f32_16x16x32_bf16 v[96:99], v[164:167], v[208:211], v[96:99]
    s_add_u32 m0, s56, 81920
    s_add_u32 s57, s55, s45
    s_mov_b64 exec, s[68:69]
    buffer_load_dwordx4 v16, s[24:27], s57 offen lds
    s_mov_b64 exec, -1
    v_mfma_f32_16x16x32_bf16 v[100:103], v[164:167], v[212:215], v[100:103]
    v_mfma_f32_16x16x32_bf16 v[104:107], v[168:171], v[196:199], v[104:107]
    v_mfma_f32_16x16x32_bf16 v[108:111], v[168:171], v[200:203], v[108:111]
    s_add_u32 m0, s56, 92160
    s_nop 0
    buffer_load_dwordx4 v8, s[28:31], s46 offen lds
    v_mfma_f32_16x16x32_bf16 v[112:115], v[168:171], v[204:207], v[112:115]
    v_mfma_f32_16x16x32_bf16 v[116:119], v[168:171], v[208:211], v[116:119]
    v_mfma_f32_16x16x32_bf16 v[120:123], v[168:171], v[212:215], v[120:123]
    s_add_u32 m0, s56, 96256
    s_nop 0
    buffer_load_dwordx4 v9, s[28:31], s46 offen lds
    v_mfma_f32_16x16x32_bf16 v[124:127], v[172:175], v[196:199], v[124:127]
    v_mfma_f32_16x16x32_bf16 v[128:131], v[172:175], v[200:203], v[128:131]
    s_add_u32 m0, s56, 100352
    s_nop 0
    buffer_load_dwordx4 v10, s[28:31], s46 offen lds
    v_mfma_f32_16x16x32_bf16 v[132:135], v[172:175], v[204:207], v[132:135]
    v_mfma_f32_16x16x32_bf16 v[136:139], v[172:175], v[208:211], v[136:139]
    s_add_u32 m0, s56, 104448
    s_nop 0
    buffer_load_dwordx4 v11, s[28:31], s46 offen lds
    v_mfma_f32_16x16x32_bf16 v[140:143], v[172:175], v[212:215], v[140:143]
    s_cmp_lg_u32 s44, 1
    s_cbranch_scc1 L_a_ns5
    v_mfma_f32_16x16x32_bf16 v[216:219], v[36:39], v[196:199], v[216:219]
    v_mfma_f32_16x16x32_bf16 v[220:223], v[196:199], v[196:199], v[220:223]
    v_mfma_f32_16x16x32_bf16 v[224:227], v[36:39], v[200:203], v[224:227]
    v_mfma_f32_16x16x32_bf16 v[228:231], v[200:203], v[200:203], v[228:231]
    v_mfma_f32_16x16x32_bf16 v[232:235], v[36:39], v[204:207], v[232:235]
    v_mfma_f32_16x16x32_bf16 v[236:239], v[204:207], v[204:207], v[236:239]
    v_mfma_f32_16x16x32_bf16 v[240:243], v[36:39], v[208:211], v[240:243]
    v_mfma_f32_16x16x32_bf16 v[244:247], v[208:211], v[208:211], v[244:247]
    v_mfma_f32_16x16x32_bf16 v[248:251], v[36:39], v[212:215], v[248:251]
    v_mfma_f32_16x16x32_bf16 v[252:255], v[212:215], v[212:215], v[252:255]
L_a_ns5:
    s_waitcnt lgkmcnt(0)
    v_mfma_f32_16x16x32_bf16 v[64:67], v[144:147], v[176:179], v[64:67]
    ds_read_b64_tr_b16 v[160:161], v23 offset:15360
    ds_read_b64_tr_b16 v[162:163], v23 offset:19200
    v_mfma_f32_16x16x32_bf16 v[68:71], v[144:147], v[180:183], v[68:71]
    ds_read_b64_tr_b16 v[164:165], v23 offset:15392
    ds_read_b64_tr_b16 v[166:167], v23 offset:19232
    v_mfma_f32_16x16x32_bf16 v[72:75], v[144:147], v[184:187], v[72:75]
    ds_read_b64_tr_b16 v[168:169], v23 offset:15424
    ds_read_b64_tr_b16 v[170:171], v23 offset:19264
    s_add_u32 m0, s56, 86016
    s_add_u32 s57, s54, 40960
    s_add_u32 s57, s57, s45
    buffer_load_dwordx4 v16, s[24:27], s57 offen lds
    v_mfma_f32_16x16x32_bf16 v[76:79], v[144:147], v[188:191], v[76:79]
    ds_read_b64_tr_b16 v[172:173], v23 offset:15456
    ds_read_b64_tr_b16 v[174:175], v23 offset:19296
    v_mfma_f32_16x16x32_bf16 v[80:83], v[144:147], v[192:195], v[80:83]
    ds_read_b128 v[196:199], v18 offset:0
    ds_read_b128 v[200:203], v18 offset:2048
    v_mfma_f32_16x16x32_bf16 v[84:87], v[148:151], v[176:179], v[84:87]
    ds_read_b128 v[204:207], v18 offset:4096
    ds_read_b128 v[208:211], v18 offset:6144
    v_mfma_f32_16x16x32_bf16 v[88:91], v[148:151], v[180:183], v[88:91]
    ds_read_b128 v[212:215], v18 offset:8192
    s_add_u32 m0, s56, 108544
    s_nop 0
    buffer_load_dwordx4 v12, s[28:31], s46 offen lds
    v_mfma_f32_16x16x32_bf16 v[92:95], v[148:151], v[184:187], v[92:95]
    v_mfma_f32_16x16x32_bf16 v[96:99], v[148:151], v[188:191], v[96:99]
    v_mfma_f32_16x16x32_bf16 v[100:103], v[148:151], v[192:195], v[100:103]
    v_mfma_f32_16x16x32_bf16 v[104:107], v[152:155], v[176:179], v[104:107]
    s_add_u32 m0, s56, 112640
    s_nop 0
    buffer_load_dwordx4 v13, s[28:31], s46 offen lds
    v_mfma_f32_16x16x32_bf16 v[108:111], v[152:155], v[180:183], v[108:111]
    v_mfma_f32_16x16x32_bf16 v[112:115], v[152:155], v[184:187], v[112:115]
    v_mfma_f32_16x16x32_bf16 v[116:119], v[152:155], v[188:191], v[116:119]
    v_mfma_f32_16x16x32_bf16 v[120:123], v[152:155], v[192:195], v[120:123]
    s_add_u32 m0, s56, 116736
    s_nop 0
    buffer_load_dwordx4 v14, s[28:31], s46 offen lds
    v_mfma_f32_16x16x32_bf16 v[124:127], v[156:159], v[176:179], v[124:127]
    v_mfma_f32_16x16x32_bf16 v[128:131], v[156:159], v[180:183], v[128:131]
    v_mfma_f32_16x16x32_bf16 v[132:135], v[156:159], v[184:187], v[132:135]
    v_mfma_f32_16x16x32_bf16 v[136:139], v[156:159], v[188:191], v[136:139]
    s_cmp_lt_u32 s44, 2
    s_cbranch_scc0 L_a_w6
    s_add_u32 m0, s56, 90112
    s_add_u32 s57, s54, 81920
    s_add_u32 s57, s57, s45
    buffer_load_dwordx4 v16, s[24:27], s57 offen lds
    s_branch L_a_e6
L_a_w6:
    s_add_u32 m0, s56, 118784
    s_nop 0
    buffer_load_dwordx4 v15, s[28:31], s46 offen lds
L_a_e6:
    s_add_u32 s45, s45, 128
    s_add_u32 s46, s46, 245760
    s_cmp_ge_u32 s45, 1280
    s_cselect_b32 s66, 1280, 0
    s_cselect_b32 s67, 2457600, 0
    s_sub_u32 s45, s45, s66
    s_sub_u32 s46, s46, s67
    v_mfma_f32_16x16x32_bf16 v[140:143], v[156:159], v[192:195], v[140:143]
    s_cmp_lg_u32 s44, 2
    s_cbranch_scc1 L_a_ns6
    v_mfma_f32_16x16x32_bf16 v[216:219], v[36:39], v[176:179], v[216:219]
    v_mfma_f32_16x16x32_bf16 v[220:223], v[176:179], v[176:179], v[220:223]
    v_mfma_f32_16x16x32_bf16 v[224:227], v[36:39], v[180:183], v[224:227]
    v_mfma_f32_16x16x32_bf16 v[228:231], v[180:183], v[180:183], v[228:231]
    v_mfma_f32_16x16x32_bf16 v[232:235], v[36:39], v[184:187], v[232:235]
    v_mfma_f32_16x16x32_bf16 v[236:239], v[184:187], v[184:187], v[236:239]
    v_mfma_f32_16x16x32_bf16 v[240:243], v[36:39], v[188:191], v[240:243]
    v_mfma_f32_16x16x32_bf16 v[244:247], v[188:191], v[188:191], v[244:247]
    v_mfma_f32_16x16x32_bf16 v[248:251], v[36:39], v[192:195], v[248:251]
    v_mfma_f32_16x16x32_bf16 v[252:255], v[192:195], v[192:195], v[252:255]
L_a_ns6:
    s_waitcnt lgkmcnt(0)
    v_mfma_f32_16x16x32_bf16 v[64:67], v[160:163], v[196:199], v[64:67]
    v_mfma_f32_16x16x32_bf16 v[68:71], v[160:163], v[200:203], v[68:71]
    v_mfma_f32_16x16x32_bf16 v[72:75], v[160:163], v[204:207], v[72:75]
    v_mfma_f32_16x16x32_bf16 v[76:79], v[160:163], v[208:211], v[76:79]
    v_mfma_f32_16x16x32_bf16 v[80:83], v[160:163], v[212:215], v[80:83]
    v_mfma_f32_16x16x32_bf16 v[84:87], v[164:167], v[196:199], v[84:87]
    s_waitcnt vmcnt(10)
    s_barrier
    ds_read_b64_tr_b16 v[144:145], v24 offset:0
    ds_read_b64_tr_b16 v[146:147], v24 offset:3840
    ds_read_b64_tr_b16 v[148:149], v24 offset:32
    ds_read_b64_tr_b16 v[150:151], v24 offset:3872
    ds_read_b64_tr_b16 v[152:153], v24 offset:64
    ds_read_b64_tr_b16 v[154:155], v24 offset:3904
    ds_read_b64_tr_b16 v[156:157], v24 offset:96
    ds_read_b64_tr_b16 v[158:159], v24 offset:3936
    ds_read_b128 v[176:179], v19 offset:0
    ds_read_b128 v[180:183], v19 offset:2048
    ds_read_b128 v[184:187], v19 offset:4096
    ds_read_b128 v[188:191], v19 offset:6144
    ds_read_b128 v[192:195], v19 offset:8192
    v_mfma_f32_16x16x32_bf16 v[88:91], v[164:167], v[200:203], v[88:91]
    v_mfma_f32_16x16x32_bf16 v[92:95], v[164:167], v[204:207], v[92:95]
    v_mfma_f32_16x16x32_bf16 v[96:99], v[164:167], v[208:211], v[96:99]
    s_add_u32 m0, s56, 0
    s_add_u32 s57, s55, s45
    s_mov_b64 exec, s[68:69]
    buffer_load_dwordx4 v16, s[24:27], s57 offen lds
    s_mov_b64 exec, -1
    v_mfma_f32_16x16x32_bf16 v[100:103], v[164:167], v[212:215], v[100:103]
    v_mfma_f32_16x16x32_bf16 v[104:107], v[168:171], v[196:199], v[104:107]
    v_mfma_f32_16x16x32_bf16 v[108:111], v[168:171], v[200:203], v[108:111]
    s_add_u32 m0, s56, 10240
    s_nop 0
    buffer_load_dwordx4 v8, s[28:31], s46 offen lds
    v_mfma_f32_16x16x32_bf16 v[112:115], v[168:171], v[204:207], v[112:115]
    v_mfma_f32_16x16x32_bf16 v[116:119], v[168:171], v[208:211], v[116:119]
    v_mfma_f32_16x16x32_bf16 v[120:123], v[168:171], v[212:215], v[120:123]
    s_add_u32 m0, s56, 14336
    s_nop 0
    buffer_load_dwordx4 v9, s[28:31], s46 offen lds
    v_mfma_f32_16x16x32_bf16 v[124:127], v[172:175], v[196:199], v[124:127]
    v_mfma_f32_16x16x32_bf16 v[128:131], v[172:175], v[200:203], v[128:131]
    s_add_u32 m0, s56, 18432
    s_nop 0
    buffer_load_dwordx4 v10, s[28:31], s46 offen lds
    v_mfma_f32_16x16x32_bf16 v[132:135], v[172:175], v[204:207], v[132:135]
    v_mfma_f32_16x16x32_bf16 v[136:139], v[172:175], v[208:211], v[136:139]
    s_add_u32 m0, s56, 22528
    s_nop 0
    buffer_load_dwordx4 v11, s[28:31], s46 offen lds
    v_mfma_f32_16x16x32_bf16 v[140:143], v[172:175], v[212:215], v[140:143]
    s_cmp_lg_u32 s44, 3
    s_cbranch_scc1 L_a_ns7
    v_mfma_f32_16x16x32_bf16 v[216:219], v[36:39], v[196:199], v[216:219]
    v_mfma_f32_16x16x32_bf16 v[220:223], v[196:199], v[196:199], v[220:223]
    v_mfma_f32_16x16x32_bf16 v[224:227], v[36:39], v[200:203], v[224:227]
    v_mfma_f32_16x16x32_bf16 v[228:231], v[200:203], v[200:203], v[228:231]
    v_mfma_f32_16x16x32_bf16 v[232:235], v[36:39], v[204:207], v[232:235]
    v_mfma_f32_16x16x32_bf16 v[236:239], v[204:207], v[204:207], v[236:239]
    v_mfma_f32_16x16x32_bf16 v[240:243], v[36:39], v[208:211], v[240:243]
    v_mfma_f32_16x16x32_bf16 v[244:247], v[208:211], v[208:211], v[244:247]
    v_mfma_f32_16x16x32_bf16 v[248:251], v[36:39], v[212:215], v[248:251]
    v_mfma_f32_16x16x32_bf16 v[252:255], v[212:215], v[212:215], v[252:255]
L_a_ns7:
    s_waitcnt lgkmcnt(0)
    v_mfma_f32_16x16x32_bf16 v[64:67], v[144:147], v[176:179], v[64:67]
    ds_read_b64_tr_b16 v[160:161], v24 offset:15360
    ds_read_b64_tr_b16 v[162:163], v24 offset:19200
    v_mfma_f32_16x16x32_bf16 v[68:71], v[144:147], v[180:183], v[68:71]
    ds_read_b64_tr_b16 v[164:165], v24 offset:15392
    ds_read_b64_tr_b16 v[166:167], v24 offset:19232
    v_mfma_f32_16x16x32_bf16 v[72:75], v[144:147], v[184:187], v[72:75]
    ds_read_b64_tr_b16 v[168:169], v24 offset:15424
    ds_read_b64_tr_b16 v[170:171], v24 offset:19264
    s_add_u32 m0, s56, 4096
    s_add_u32 s57, s54, 40960
    s_add_u32 s57, s57, s45
    buffer_load_dwordx4 v16, s[24:27], s57 offen lds
    v_mfma_f32_16x16x32_bf16 v[76:79], v[144:147], v[188:191], v[76:79]
    ds_read_b64_tr_b16 v[172:173], v24 offset:15456
    ds_read_b64_tr_b16 v[174:175], v24 offset:19296
    v_mfma_f32_16x16x32_bf16 v[80:83], v[144:147], v[192:195], v[80:83]
    ds_read_b128 v[196:199], v20 offset:0
    ds_read_b128 v[200:203], v20 offset:2048
    v_mfma_f32_16x16x32_bf16 v[84:87], v[148:151], v[176:179], v[84:87]
    ds_read_b128 v[204:207], v20 offset:4096
    ds_read_b128 v[208:211], v20 offset:6144
    v_mfma_f32_16x16x32_bf16 v[88:91], v[148:151], v[180:183], v[88:91]
    ds_read_b128 v[212:215], v20 offset:8192
    s_add_u32 m0, s56, 26624
    s_nop 0
    buffer_load_dwordx4 v12, s[28:31], s46 offen lds
    v_mfma_f32_16x16x32_bf16 v[92:95], v[148:151], v[184:187], v[92:95]
    v_mfma_f32_16x16x32_bf16 v[96:99], v[148:151], v[188:191], v[96:99]
    v_mfma_f32_16x16x32_bf16 v[100:103], v[148:151], v[192:195], v[100:103]
    v_mfma_f32_16x16x32_bf16 v[104:107], v[152:155], v[176:179], v[104:107]
    s_add_u32 m0, s56, 30720
    s_nop 0
    buffer_load_dwordx4 v13, s[28:31], s46 offen lds
    v_mfma_f32_16x16x32_bf16 v[108:111], v[152:155], v[180:183], v[108:111]
    v_mfma_f32_16x16x32_bf16 v[112:115], v[152:155], v[184:187], v[112:115]
    v_mfma_f32_16x16x32_bf16 v[116:119], v[152:155], v[188:191], v[116:119]
    v_mfma_f32_16x16x32_bf16 v[120:123], v[152:155], v[192:195], v[120:123]
    s_add_u32 m0, s56, 34816
    s_nop 0
    buffer_load_dwordx4 v14, s[28:31], s46 offen lds
    v_mfma_f32_16x16x32_bf16 v[124:127], v[156:159], v[176:179], v[124:127]
    v_mfma_f32_16x16x32_bf16 v[128:131], v[156:159], v[180:183], v[128:131]
    v_mfma_f32_16x16x32_bf16 v[132:135], v[156:159], v[184:187], v[132:135]
    v_mfma_f32_16x16x32_bf16 v[136:139], v[156:159], v[188:191], v[136:139]
    s_cmp_lt_u32 s44, 2
    s_cbranch_scc0 L_a_w7
    s_add_u32 m0, s56, 8192
    s_add_u32 s57, s54, 81920
    s_add_u32 s57, s57, s45
    buffer_load_dwordx4 v16, s[24:27], s57 offen lds
    s_branch L_a_e7
L_a_w7:
    s_add_u32 m0, s56, 36864
    s_nop 0
    buffer_load_dwordx4 v15, s[28:31], s46 offen lds
L_a_e7:
    s_add_u32 s45, s45, 128
    s_add_u32 s46, s46, 245760
    s_cmp_ge_u32 s45, 1280
    s_cselect_b32 s66, 1280, 0
    s_cselect_b32 s67, 2457600, 0
    s_sub_u32 s45, s45, s66
    s_sub_u32 s46, s46, s67
    v_mfma_f32_16x16x32_bf16 v[140:143], v[156:159], v[192:195], v[140:143]
    s_cmp_lg_u32 s44, 0
    s_cbranch_scc1 L_a_ns8
    v_mfma_f32_16x16x32_bf16 v[216:219], v[36:39], v[176:179], v[216:219]
    v_mfma_f32_16x16x32_bf16 v[220:223], v[176:179], v[176:179], v[220:223]
    v_mfma_f32_16x16x32_bf16 v[224:227], v[36:39], v[180:183], v[224:227]
    v_mfma_f32_16x16x32_bf16 v[228:231], v[180:183], v[180:183], v[228:231]
    v_mfma_f32_16x16x32_bf16 v[232:235], v[36:39], v[184:187], v[232:235]
    v_mfma_f32_16x16x32_bf16 v[236:239], v[184:187], v[184:187], v[236:239]
    v_mfma_f32_16x16x32_bf16 v[240:243], v[36:39], v[188:191], v[240:243]
    v_mfma_f32_16x16x32_bf16 v[244:247], v[188:191], v[188:191], v[244:247]
    v_mfma_f32_16x16x32_bf16 v[248:251], v[36:39], v[192:195], v[248:251]
    v_mfma_f32_16x16x32_bf16 v[252:255], v[192:195], v[192:195], v[252:255]
L_a_ns8:
    s_waitcnt lgkmcnt(0)
    v_mfma_f32_16x16x32_bf16 v[64:67], v[160:163], v[196:199], v[64:67]
    v_mfma_f32_16x16x32_bf16 v[68:71], v[160:163], v[200:203], v[68:71]
    v_mfma_f32_16x16x32_bf16 v[72:75], v[160:163], v[204:207], v[72:75]
    v_mfma_f32_16x16x32_bf16 v[76:79], v[160:163], v[208:211], v[76:79]
    v_mfma_f32_16x16x32_bf16 v[80:83], v[160:163], v[212:215], v[80:83]
    v_mfma_f32_16x16x32_bf16 v[84:87], v[164:167], v[196:199], v[84:87]
    s_waitcnt vmcnt(10)
    s_barrier
    ds_read_b64_tr_b16 v[144:145], v25 offset:0
    ds_read_b64_tr_b16 v[146:147], v25 offset:3840
    ds_read_b64_tr_b16 v[148:149], v25 offset:32
    ds_read_b64_tr_b16 v[150:151], v25 offset:3872
    ds_read_b64_tr_b16 v[152:153], v25 offset:64
    ds_read_b64_tr_b16 v[154:155], v25 offset:3904
    ds_read_b64_tr_b16 v[156:157], v25 offset:96
    ds_read_b64_tr_b16 v[158:159], v25 offset:3936
    ds_read_b128 v[176:179], v21 offset:0
    ds_read_b128 v[180:183], v21 offset:2048
    ds_read_b128 v[184:187], v21 offset:4096
    ds_read_b128 v[188:191], v21 offset:6144
    ds_read_b128 v[192:195], v21 offset:8192
    v_mfma_f32_16x16x32_bf16 v[88:91], v[164:167], v[200:203], v[88:91]
    v_mfma_f32_16x16x32_bf16 v[92:95], v[164:167], v[204:207], v[92:95]
    v_mfma_f32_16x16x32_bf16 v[96:99], v[164:167], v[208:211], v[96:99]
    s_add_u32 m0, s56, 40960
    s_add_u32 s57, s55, s45
    s_mov_b64 exec, s[68:69]
    buffer_load_dwordx4 v16, s[24:27], s57 offen lds
    s_mov_b64 exec, -1
    v_mfma_f32_16x16x32_bf16 v[100:103], v[164:167], v[212:215], v[100:103]
    v_mfma_f32_16x16x32_bf16 v[104:107], v[168:171], v[196:199], v[104:107]
    v_mfma_f32_16x16x32_bf16 v[108:111], v[168:171], v[200:203], v[108:111]
    s_add_u32 m0, s56, 51200
    s_nop 0
    buffer_load_dwordx4 v8, s[28:31], s46 offen lds
    v_mfma_f32_16x16x32_bf16 v[112:115], v[168:171], v[204:207], v[112:115]
    v_mfma_f32_16x16x32_bf16 v[116:119], v[168:171], v[208:211], v[116:119]
    v_mfma_f32_16x16x32_bf16 v[120:123], v[168:171], v[212:215], v[120:123]
    s_add_u32 m0, s56, 55296
    s_nop 0
    buffer_load_dwordx4 v9, s[28:31], s46 offen lds
    v_mfma_f32_16x16x32_bf16 v[124:127], v[172:175], v[196:199], v[124:127]
    v_mfma_f32_16x16x32_bf16 v[128:131], v[172:175], v[200:203], v[128:131]
    s_add_u32 m0, s56, 59392
    s_nop 0
    buffer_load_dwordx4 v10, s[28:31], s46 offen lds
    v_mfma_f32_16x16x32_bf16 v[132:135], v[172:175], v[204:207], v[132:135]
    v_mfma_f32_16x16x32_bf16 v[136:139], v[172:175], v[208:211], v[136:139]
    s_add_u32 m0, s56, 63488
    s_nop 0
    buffer_load_dwordx4 v11, s[28:31], s46 offen lds
    v_mfma_f32_16x16x32_bf16 v[140:143], v[172:175], v[212:215], v[140:143]
    s_cmp_lg_u32 s44, 1
    s_cbranch_scc1 L_a_ns9
    v_mfma_f32_16x16x32_bf16 v[216:219], v[36:39], v[196:199], v[216:219]
    v_mfma_f32_16x16x32_bf16 v[220:223], v[196:199], v[196:199], v[220:223]
    v_mfma_f32_16x16x32_bf16 v[224:227], v[36:39], v[200:203], v[224:227]
    v_mfma_f32_16x16x32_bf16 v[228:231], v[200:203], v[200:203], v[228:231]
    v_mfma_f32_16x16x32_bf16 v[232:235], v[36:39], v[204:207], v[232:235]
    v_mfma_f32_16x16x32_bf16 v[236:239], v[204:207], v[204:207], v[236:239]
    v_mfma_f32_16x16x32_bf16 v[240:243], v[36:39], v[208:211], v[240:243]
    v_mfma_f32_16x16x32_bf16 v[244:247], v[208:211], v[208:211], v[244:247]
    v_mfma_f32_16x16x32_bf16 v[248:251], v[36:39], v[212:215], v[248:251]
    v_mfma_f32_16x16x32_bf16 v[252:255], v[212:215], v[212:215], v[252:255]
L_a_ns9:
    s_waitcnt lgkmcnt(0)
    v_mfma_f32_16x16x32_bf16 v[64:67], v[144:147], v[176:179], v[64:67]
    ds_read_b64_tr_b16 v[160:161], v25 offset:15360
    ds_read_b64_tr_b16 v[162:163], v25 offset:19200
    v_mfma_f32_16x16x32_bf16 v[68:71], v[144:147], v[180:183], v[68:71]
    ds_read_b64_tr_b16 v[164:165], v25 offset:15392
    ds_read_b64_tr_b16 v[166:167], v25 offset:19232
    v_mfma_f32_16x16x32_bf16 v[72:75], v[144:147], v[184:187], v[72:75]
    ds_read_b64_tr_b16 v[168:169], v25 offset:15424
    ds_read_b64_tr_b16 v[170:171], v25 offset:19264
    s_add_u32 m0, s56, 45056
    s_add_u32 s57, s54, 40960
    s_add_u32 s57, s57, s45
    buffer_load_dwordx4 v16, s[24:27], s57 offen lds
    v_mfma_f32_16x16x32_bf16 v[76:79], v[144:147], v[188:191], v[76:79]
    ds_read_b64_tr_b16 v[172:173], v25 offset:15456
    ds_read_b64_tr_b16 v[174:175], v25 offset:19296
    v_mfma_f32_16x16x32_bf16 v[80:83], v[144:147], v[192:195], v[80:83]
    ds_read_b128 v[196:199], v22 offset:0
    ds_read_b128 v[200:203], v22 offset:2048
    v_mfma_f32_16x16x32_bf16 v[84:87], v[148:151], v[176:179], v[84:87]
    ds_read_b128 v[204:207], v22 offset:4096
    ds_read_b128 v[208:211], v22 offset:6144
    v_mfma_f32_16x16x32_bf16 v[88:91], v[148:151], v[180:183], v[88:91]
    ds_read_b128 v[212:215], v22 offset:8192
    s_add_u32 m0, s56, 67584
    s_nop 0
    buffer_load_dwordx4 v12, s[28:31], s46 offen lds
    v_mfma_f32_16x16x32_bf16 v[92:95], v[148:151], v[184:187], v[92:95]
    v_mfma_f32_16x16x32_bf16 v[96:99], v[148:151], v[188:191], v[96:99]
    v_mfma_f32_16x16x32_bf16 v[100:103], v[148:151], v[192:195], v[100:103]
    v_mfma_f32_16x16x32_bf16 v[104:107], v[152:155], v[176:179], v[104:107]
    s_add_u32 m0, s56, 71680
    s_nop 0
    buffer_load_dwordx4 v13, s[28:31], s46 offen lds
    v_mfma_f32_16x16x32_bf16 v[108:111], v[152:155], v[180:183], v[108:111]
    v_mfma_f32_16x16x32_bf16 v[112:115], v[152:155], v[184:187], v[112:115]
    v_mfma_f32_16x16x32_bf16 v[116:119], v[152:155], v[188:191], v[116:119]
    v_mfma_f32_16x16x32_bf16 v[120:123], v[152:155], v[192:195], v[120:123]
    s_add_u32 m0, s56, 75776
    s_nop 0
    buffer_load_dwordx4 v14, s[28:31], s46 offen lds
    v_mfma_f32_16x16x32_bf16 v[124:127], v[156:159], v[176:179], v[124:127]
    v_mfma_f32_16x16x32_bf16 v[128:131], v[156:159], v[180:183], v[128:131]
    v_mfma_f32_16x16x32_bf16 v[132:135], v[156:159], v[184:187], v[132:135]
    v_mfma_f32_16x16x32_bf16 v[136:139], v[156:159], v[188:191], v[136:139]
    s_cmp_lt_u32 s44, 2
    s_cbranch_scc0 L_a_w8
    s_add_u32 m0, s56, 49152
    s_add_u32 s57, s54, 81920
    s_add_u32 s57, s57, s45
    buffer_load_dwordx4 v16, s[24:27], s57 offen lds
    s_branch L_a_e8
L_a_w8:
    s_add_u32 m0, s56, 77824
    s_nop 0
    buffer_load_dwordx4 v15, s[28:31], s46 offen lds
L_a_e8:
    s_add_u32 s45, s45, 128
    s_add_u32 s46, s46, 245760
    s_cmp_ge_u32 s45, 1280
    s_cselect_b32 s66, 1280, 0
    s_cselect_b32 s67, 2457600, 0
    s_sub_u32 s45, s45, s66
    s_sub_u32 s46, s46, s67
    v_mfma_f32_16x16x32_bf16 v[140:143], v[156:159], v[192:195], v[140:143]
    s_cmp_lg_u32 s44, 2
    s_cbranch_scc1 L_a_ns10
    v_mfma_f32_16x16x32_bf16 v[216:219], v[36:39], v[176:179], v[216:219]
    v_mfma_f32_16x16x32_bf16 v[220:223], v[176:179], v[176:179], v[220:223]
    v_mfma_f32_16x16x32_bf16 v[224:227], v[36:39], v[180:183], v[224:227]
    v_mfma_f32_16x16x32_bf16 v[228:231], v[180:183], v[180:183], v[228:231]
    v_mfma_f32_16x16x32_bf16 v[232:235], v[36:39], v[184:187], v[232:235]
    v_mfma_f32_16x16x32_bf16 v[236:239], v[184:187], v[184:187], v[236:239]
    v_mfma_f32_16x16x32_bf16 v[240:243], v[36:39], v[188:191], v[240:243]
    v_mfma_f32_16x16x32_bf16 v[244:247], v[188:191], v[188:191], v[244:247]
    v_mfma_f32_16x16x32_bf16 v[248:251], v[36:39], v[192:195], v[248:251]
    v_mfma_f32_16x16x32_bf16 v[252:255], v[192:195], v[192:195], v[252:255]
L_a_ns10:
    s_waitcnt lgkmcnt(0)
    v_mfma_f32_16x16x32_bf16 v[64:67], v[160:163], v[196:199], v[64:67]
    v_mfma_f32_16x16x32_bf16 v[68:71], v[160:163], v[200:203], v[68:71]
    v_mfma_f32_16x16x32_bf16 v[72:75], v[160:163], v[204:207], v[72:75]
    v_mfma_f32_16x16x32_bf16 v[76:79], v[160:163], v[208:211], v[76:79]
    v_mfma_f32_16x16x32_bf16 v[80:83], v[160:163], v[212:215], v[80:83]
    v_mfma_f32_16x16x32_bf16 v[84:87], v[164:167], v[196:199], v[84:87]
    s_waitcnt vmcnt(10)
    s_barrier
    ds_read_b64_tr_b16 v[144:145], v23 offset:0
    ds_read_b64_tr_b16 v[146:147], v23 offset:3840
    ds_read_b64_tr_b16 v[148:149], v23 offset:32
    ds_read_b64_tr_b16 v[150:151], v23 offset:3872
    ds_read_b64_tr_b16 v[152:153], v23 offset:64
    ds_read_b64_tr_b16 v[154:155], v23 offset:3904
    ds_read_b64_tr_b16 v[156:157], v23 offset:96
    ds_read_b64_tr_b16 v[158:159], v23 offset:3936
    ds_read_b128 v[176:179], v17 offset:0
    ds_read_b128 v[180:183], v17 offset:2048
    ds_read_b128 v[184:187], v17 offset:4096
    ds_read_b128 v[188:191], v17 offset:6144
    ds_read_b128 v[192:195], v17 offset:8192
    v_mfma_f32_16x16x32_bf16 v[88:91], v[164:167], v[200:203], v[88:91]
    v_mfma_f32_16x16x32_bf16 v[92:95], v[164:167], v[204:207], v[92:95]
    v_mfma_f32_16x16x32_bf16 v[96:99], v[164:167], v[208:211], v[96:99]
    s_add_u32 m0, s56, 81920
    s_add_u32 s57, s55, s45
    s_mov_b64 exec, s[68:69]
    buffer_load_dwordx4 v16, s[24:27], s57 offen lds
    s_mov_b64 exec, -1
    v_mfma_f32_16x16x32_bf16 v[100:103], v[164:167], v[212:215], v[100:103]
    v_mfma_f32_16x16x32_bf16 v[104:107], v[168:171], v[196:199], v[104:107]
    v_mfma_f32_16x16x32_bf16 v[108:111], v[168:171], v[200:203], v[108:111]
    s_add_u32 m0, s56, 92160
    s_nop 0
    buffer_load_dwordx4 v8, s[28:31], s46 offen lds
    v_mfma_f32_16x16x32_bf16 v[112:115], v[168:171], v[204:207], v[112:115]
    v_mfma_f32_16x16x32_bf16 v[116:119], v[168:171], v[208:211], v[116:119]
    v_mfma_f32_16x16x32_bf16 v[120:123], v[168:171], v[212:215], v[120:123]
    s_add_u32 m0, s56, 96256
    s_nop 0
    buffer_load_dwordx4 v9, s[28:31], s46 offen lds
    v_mfma_f32_16x16x32_bf16 v[124:127], v[172:175], v[196:199], v[124:127]
    v_mfma_f32_16x16x32_bf16 v[128:131], v[172:175], v[200:203], v[128:131]
    s_add_u32 m0, s56, 100352
    s_nop 0
    buffer_load_dwordx4 v10, s[28:31], s46 offen lds
    v_mfma_f32_16x16x32_bf16 v[132:135], v[172:175], v[204:207], v[132:135]
    v_mfma_f32_16x16x32_bf16 v[136:139], v[172:175], v[208:211], v[136:139]
    s_add_u32 m0, s56, 104448
    s_nop 0
    buffer_load_dwordx4 v11, s[28:31], s46 offen lds
    v_mfma_f32_16x16x32_bf16 v[140:143], v[172:175], v[212:215], v[140:143]
    s_cmp_lg_u32 s44, 3
    s_cbranch_scc1 L_a_ns11
    v_mfma_f32_16x16x32_bf16 v[216:219], v[36:39], v[196:199], v[216:219]
    v_mfma_f32_16x16x32_bf16 v[220:223], v[196:199], v[196:199], v[220:223]
    v_mfma_f32_16x16x32_bf16 v[224:227], v[36:39], v[200:203], v[224:227]
    v_mfma_f32_16x16x32_bf16 v[228:231], v[200:203], v[200:203], v[228:231]
    v_mfma_f32_16x16x32_bf16 v[232:235], v[36:39], v[204:207], v[232:235]
    v_mfma_f32_16x16x32_bf16 v[236:239], v[204:207], v[204:207], v[236:239]
    v_mfma_f32_16x16x32_bf16 v[240:243], v[36:39], v[208:211], v[240:243]
    v_mfma_f32_16x16x32_bf16 v[244:247], v[208:211], v[208:211], v[244:247]
    v_mfma_f32_16x16x32_bf16 v[248:251], v[36:39], v[212:215], v[248:251]
    v_mfma_f32_16x16x32_bf16 v[252:255], v[212:215], v[212:215], v[252:255]
L_a_ns11:
    s_waitcnt lgkmcnt(0)
    v_mfma_f32_16x16x32_bf16 v[64:67], v[144:147], v[176:179], v[64:67]
    ds_read_b64_tr_b16 v[160:161], v23 offset:15360
    ds_read_b64_tr_b16 v[162:163], v23 offset:19200
    v_mfma_f32_16x16x32_bf16 v[68:71], v[144:147], v[180:183], v[68:71]
    ds_read_b64_tr_b16 v[164:165], v23 offset:15392
    ds_read_b64_tr_b16 v[166:167], v23 offset:19232
    v_mfma_f32_16x16x32_bf16 v[72:75], v[144:147], v[184:187], v[72:75]
    ds_read_b64_tr_b16 v[168:169], v23 offset:15424
    ds_read_b64_tr_b16 v[170:171], v23 offset:19264
    s_add_u32 m0, s56, 86016
    s_add_u32 s57, s54, 40960
    s_add_u32 s57, s57, s45
    buffer_load_dwordx4 v16, s[24:27], s57 offen lds
    v_mfma_f32_16x16x32_bf16 v[76:79], v[144:147], v[188:191], v[76:79]
    ds_read_b64_tr_b16 v[172:173], v23 offset:15456
    ds_read_b64_tr_b16 v[174:175], v23 offset:19296
    v_mfma_f32_16x16x32_bf16 v[80:83], v[144:147], v[192:195], v[80:83]
    ds_read_b128 v[196:199], v18 offset:0
    ds_read_b128 v[200:203], v18 offset:2048
    v_mfma_f32_16x16x32_bf16 v[84:87], v[148:151], v[176:179], v[84:87]
    ds_read_b128 v[204:207], v18 offset:4096
    ds_read_b128 v[208:211], v18 offset:6144
    v_mfma_f32_16x16x32_bf16 v[88:91], v[148:151], v[180:183], v[88:91]
    ds_read_b128 v[212:215], v18 offset:8192
    s_add_u32 m0, s56, 108544
    s_nop 0
    buffer_load_dwordx4 v12, s[28:31], s46 offen lds
    v_mfma_f32_16x16x32_bf16 v[92:95], v[148:151], v[184:187], v[92:95]
    v_mfma_f32_16x16x32_bf16 v[96:99], v[148:151], v[188:191], v[96:99]
    v_mfma_f32_16x16x32_bf16 v[100:103], v[148:151], v[192:195], v[100:103]
    v_mfma_f32_16x16x32_bf16 v[104:107], v[152:155], v[176:179], v[104:107]
    s_add_u32 m0, s56, 112640
    s_nop 0
    buffer_load_dwordx4 v13, s[28:31], s46 offen lds
    v_mfma_f32_16x16x32_bf16 v[108:111], v[152:155], v[180:183], v[108:111]
    v_mfma_f32_16x16x32_bf16 v[112:115], v[152:155], v[184:187], v[112:115]
    v_mfma_f32_16x16x32_bf16 v[116:119], v[152:155], v[188:191], v[116:119]
    v_mfma_f32_16x16x32_bf16 v[120:123], v[152:155], v[192:195], v[120:123]
    s_add_u32 m0, s56, 116736
    s_nop 0
    buffer_load_dwordx4 v14, s[28:31], s46 offen lds
    v_mfma_f32_16x16x32_bf16 v[124:127], v[156:159], v[176:179], v[124:127]
    v_mfma_f32_16x16x32_bf16 v[128:131], v[156:159], v[180:183], v[128:131]
    v_mfma_f32_16x16x32_bf16 v[132:135], v[156:159], v[184:187], v[132:135]
    v_mfma_f32_16x16x32_bf16 v[136:139], v[156:159], v[188:191], v[136:139]
    s_cmp_lt_u32 s44, 2
    s_cbranch_scc0 L_a_w9
    s_add_u32 m0, s56, 90112
    s_add_u32 s57, s54, 81920
    s_add_u32 s57, s57, s45
    buffer_load_dwordx4 v16, s[24:27], s57 offen lds
    s_branch L_a_e9
L_a_w9:
    s_add_u32 m0, s56, 118784
    s_nop 0
    buffer_load_dwordx4 v15, s[28:31], s46 offen lds
L_a_e9:
    s_add_u32 s45, s45, 128
    s_add_u32 s46, s46, 245760
    s_cmp_ge_u32 s45, 1280
    s_cselect_b32 s66, 1280, 0
    s_cselect_b32 s67, 2457600, 0
    s_sub_u32 s45, s45, s66
    s_sub_u32 s46, s46, s67
    v_mfma_f32_16x16x32_bf16 v[140:143], v[156:159], v[192:195], v[140:143]
    s_cmp_lg_u32 s44, 0
    s_cbranch_scc1 L_a_ns12
    v_mfma_f32_16x16x32_bf16 v[216:219], v[36:39], v[176:179], v[216:219]
    v_mfma_f32_16x16x32_bf16 v[220:223], v[176:179], v[176:179], v[220:223]
    v_mfma_f32_16x16x32_bf16 v[224:227], v[36:39], v[180:183], v[224:227]
    v_mfma_f32_16x16x32_bf16 v[228:231], v[180:183], v[180:183], v[228:231]
    v_mfma_f32_16x16x32_bf16 v[232:235], v[36:39], v[184:187], v[232:235]
    v_mfma_f32_16x16x32_bf16 v[236:239], v[184:187], v[184:187], v[236:239]
    v_mfma_f32_16x16x32_bf16 v[240:243], v[36:39], v[188:191], v[240:243]
    v_mfma_f32_16x16x32_bf16 v[244:247], v[188:191], v[188:191], v[244:247]
    v_mfma_f32_16x16x32_bf16 v[248:251], v[36:39], v[192:195], v[248:251]
    v_mfma_f32_16x16x32_bf16 v[252:255], v[192:195], v[192:195], v[252:255]
L_a_ns12:
    s_waitcnt lgkmcnt(0)
    v_mfma_f32_16x16x32_bf16 v[64:67], v[160:163], v[196:199], v[64:67]
    v_mfma_f32_16x16x32_bf16 v[68:71], v[160:163], v[200:203], v[68:71]
    v_mfma_f32_16x16x32_bf16 v[72:75], v[160:163], v[204:207], v[72:75]
    v_mfma_f32_16x16x32_bf16 v[76:79], v[160:163], v[208:211], v[76:79]
    v_mfma_f32_16x16x32_bf16 v[80:83], v[160:163], v[212:215], v[80:83]
    v_mfma_f32_16x16x32_bf16 v[84:87], v[164:167], v[196:199], v[84:87]
    s_waitcnt vmcnt(10)
    s_barrier
    ds_read_b64_tr_b16 v[144:145], v24 offset:0
    ds_read_b64_tr_b16 v[146:147], v24 offset:3840
    ds_read_b64_tr_b16 v[148:149], v24 offset:32
    ds_read_b64_tr_b16 v[150:151], v24 offset:3872
    ds_read_b64_tr_b16 v[152:153], v24 offset:64
    ds_read_b64_tr_b16 v[154:155], v24 offset:3904
    ds_read_b64_tr_b16 v[156:157], v24 offset:96
    ds_read_b64_tr_b16 v[158:159], v24 offset:3936
    ds_read_b128 v[176:179], v19 offset:0
    ds_read_b128 v[180:183], v19 offset:2048
    ds_read_b128 v[184:187], v19 offset:4096
    ds_read_b128 v[188:191], v19 offset:6144
    ds_read_b128 v[192:195], v19 offset:8192
    v_add_u32 v2, 0, v1
    v_mul_u32_u24 v3, 205, v2
    v_lshrrev_b32 v3, 11, v3
    v_mul_u32_u24 v31, 10, v3
    v_sub_u32 v4, v2, v31
    v_and_b32 v5, 0x13, v3
    v_bfe_u32 v2, v3, 2, 1
    v_lshl_or_b32 v5, v2, 3, v5
    v_bfe_u32 v2, v3, 3, 1
    v_lshl_or_b32 v5, v2, 2, v5
    v_mul_u32_u24 v5, 1280, v5
    v_lshl_add_u32 v5, v4, 4, v5
    v_subrev_u32 v40, 0, v5

    v_add_u32 v2, 64, v1
    v_mul_u32_u24 v3, 205, v2
    v_lshrrev_b32 v3, 11, v3
    v_mul_u32_u24 v31, 10, v3
    v_sub_u32 v4, v2, v31
    v_and_b32 v5, 0x13, v3
    v_bfe_u32 v2, v3, 2, 1
    v_lshl_or_b32 v5, v2, 3, v5
    v_bfe_u32 v2, v3, 3, 1
    v_lshl_or_b32 v5, v2, 2, v5
    v_mul_u32_u24 v5, 1280, v5
    v_lshl_add_u32 v5, v4, 4, v5
    v_subrev_u32 v41, 1024, v5

    v_add_u32 v2, 128, v1
    v_mul_u32_u24 v3, 205, v2
    v_lshrrev_b32 v3, 11, v3
    v_mul_u32_u24 v31, 10, v3
    v_sub_u32 v4, v2, v31
    v_and_b32 v5, 0x13, v3
    v_bfe_u32 v2, v3, 2, 1
    v_lshl_or_b32 v5, v2, 3, v5
    v_bfe_u32 v2, v3, 3, 1
    v_lshl_or_b32 v5, v2, 2, v5
    v_mul_u32_u24 v5, 1280, v5
    v_lshl_add_u32 v5, v4, 4, v5
    v_subrev_u32 v42, 2048, v5

    v_add_u32 v2, 192, v1
    v_mul_u32_u24 v3, 205, v2
    v_lshrrev_b32 v3, 11, v3
    v_mul_u32_u24 v31, 10, v3
    v_sub_u32 v4, v2, v31
    v_and_b32 v5, 0x13, v3
    v_bfe_u32 v2, v3, 2, 1
    v_lshl_or_b32 v5, v2, 3, v5
    v_bfe_u32 v2, v3, 3, 1
    v_lshl_or_b32 v5, v2, 2, v5
    v_mul_u32_u24 v5, 1280, v5
    v_lshl_add_u32 v5, v4, 4, v5
    v_subrev_u32 v43, 3072, v5

    v_add_u32 v2, 256, v1
    v_mul_u32_u24 v3, 205, v2
    v_lshrrev_b32 v3, 11, v3
    v_mul_u32_u24 v31, 10, v3
    v_sub_u32 v4, v2, v31
    v_and_b32 v5, 0x13, v3
    v_bfe_u32 v2, v3, 2, 1
    v_lshl_or_b32 v5, v2, 3, v5
    v_bfe_u32 v2, v3, 3, 1
    v_lshl_or_b32 v5, v2, 2, v5
    v_mul_u32_u24 v5, 1280, v5
    v_lshl_add_u32 v5, v4, 4, v5
    v_subrev_u32 v44, 0, v5

    s_mov_b32 s40, s10
    s_mov_b32 s41, s11
    s_mov_b32 s42, 0xc8000
    s_mov_b32 s43, 0x00020000
    s_mul_i32 s47, s44, 5120
    s_add_u32 s47, s47, 0xa800
    s_mul_i32 s60, s44, 0x32000
    s_and_b32 s43, s51, 7
    s_mul_i32 s43, s43, 160
    s_add_u32 s60, s60, s43
    s_mov_b32 s43, 0x00020000
    s_lshr_b32 s48, s51, 3
    s_and_b32 s49, s51, 7
    s_add_u32 s48, s48, s49
    s_add_u32 s48, s48, s50
    s_mul_i32 s49, s48, 52
    s_lshr_b32 s49, s49, 8
    s_mul_i32 s49, s49, 5
    s_sub_u32 s48, s48, s49

    s_add_u32 s61, s60, 0x32000
    s_mul_i32 s3, s48, 0xa000
    s_add_u32 s60, s60, s3
    v_mfma_f32_16x16x32_bf16 v[88:91], v[164:167], v[200:203], v[88:91]
    v_mfma_f32_16x16x32_bf16 v[92:95], v[164:167], v[204:207], v[92:95]
    v_mfma_f32_16x16x32_bf16 v[96:99], v[164:167], v[208:211], v[96:99]
    s_add_u32 m0, s56, 0
    s_add_u32 s57, s55, s45
    s_mov_b64 exec, s[68:69]
    buffer_load_dwordx4 v16, s[24:27], s57 offen lds
    s_mov_b64 exec, -1
    s_add_u32 m0, s56, 10240
    s_nop 0
    buffer_load_dwordx4 v8, s[28:31], s46 offen lds
    v_mfma_f32_16x16x32_bf16 v[100:103], v[164:167], v[212:215], v[100:103]
    v_mfma_f32_16x16x32_bf16 v[104:107], v[168:171], v[196:199], v[104:107]
    v_mfma_f32_16x16x32_bf16 v[108:111], v[168:171], v[200:203], v[108:111]
    s_add_u32 m0, s56, 14336
    s_nop 0
    buffer_load_dwordx4 v9, s[28:31], s46 offen lds
    s_add_u32 m0, s56, 18432
    s_nop 0
    buffer_load_dwordx4 v10, s[28:31], s46 offen lds
    v_mfma_f32_16x16x32_bf16 v[112:115], v[168:171], v[204:207], v[112:115]
    v_mfma_f32_16x16x32_bf16 v[116:119], v[168:171], v[208:211], v[116:119]
    v_mfma_f32_16x16x32_bf16 v[120:123], v[168:171], v[212:215], v[120:123]
    s_add_u32 m0, s56, 22528
    s_nop 0
    buffer_load_dwordx4 v11, s[28:31], s46 offen lds
    s_add_u32 m0, s56, 4096
    s_add_u32 s57, s54, 40960
    s_add_u32 s57, s57, s45
    buffer_load_dwordx4 v16, s[24:27], s57 offen lds
    v_mfma_f32_16x16x32_bf16 v[124:127], v[172:175], v[196:199], v[124:127]
    v_mfma_f32_16x16x32_bf16 v[128:131], v[172:175], v[200:203], v[128:131]
    s_add_u32 m0, s56, 26624
    s_nop 0
    buffer_load_dwordx4 v12, s[28:31], s46 offen lds
    s_add_u32 m0, s56, 30720
    s_nop 0
    buffer_load_dwordx4 v13, s[28:31], s46 offen lds
    v_mfma_f32_16x16x32_bf16 v[132:135], v[172:175], v[204:207], v[132:135]
    v_mfma_f32_16x16x32_bf16 v[136:139], v[172:175], v[208:211], v[136:139]
    s_add_u32 m0, s56, 34816
    s_nop 0
    buffer_load_dwordx4 v14, s[28:31], s46 offen lds
    s_cmp_lt_u32 s44, 2
    s_cbranch_scc0 L_a_w10
    s_add_u32 m0, s56, 8192
    s_add_u32 s57, s54, 81920
    s_add_u32 s57, s57, s45
    buffer_load_dwordx4 v16, s[24:27], s57 offen lds
    s_branch L_a_e10
L_a_w10:
    s_add_u32 m0, s56, 36864
    s_nop 0
    buffer_load_dwordx4 v15, s[28:31], s46 offen lds
L_a_e10:
    s_add_u32 s45, s45, 128
    s_add_u32 s46, s46, 245760
    s_cmp_ge_u32 s45, 1280
    s_cselect_b32 s66, 1280, 0
    s_cselect_b32 s67, 2457600, 0
    s_sub_u32 s45, s45, s66
    s_sub_u32 s46, s46, s67
    v_mfma_f32_16x16x32_bf16 v[140:143], v[172:175], v[212:215], v[140:143]
    s_cmp_lg_u32 s44, 1
    s_cbranch_scc1 L_a_ns13
    v_mfma_f32_16x16x32_bf16 v[216:219], v[36:39], v[196:199], v[216:219]
    v_mfma_f32_16x16x32_bf16 v[220:223], v[196:199], v[196:199], v[220:223]
    v_mfma_f32_16x16x32_bf16 v[224:227], v[36:39], v[200:203], v[224:227]
    v_mfma_f32_16x16x32_bf16 v[228:231], v[200:203], v[200:203], v[228:231]
    v_mfma_f32_16x16x32_bf16 v[232:235], v[36:39], v[204:207], v[232:235]
    v_mfma_f32_16x16x32_bf16 v[236:239], v[204:207], v[204:207], v[236:239]
    v_mfma_f32_16x16x32_bf16 v[240:243], v[36:39], v[208:211], v[240:243]
    v_mfma_f32_16x16x32_bf16 v[244:247], v[208:211], v[208:211], v[244:247]
    v_mfma_f32_16x16x32_bf16 v[248:251], v[36:39], v[212:215], v[248:251]
    v_mfma_f32_16x16x32_bf16 v[252:255], v[212:215], v[212:215], v[252:255]
L_a_ns13:
    s_waitcnt lgkmcnt(0)
    v_mfma_f32_16x16x32_bf16 v[64:67], v[144:147], v[176:179], v[64:67]
    ds_read_b64_tr_b16 v[160:161], v24 offset:15360
    ds_read_b64_tr_b16 v[162:163], v24 offset:19200
    v_mfma_f32_16x16x32_bf16 v[68:71], v[144:147], v[180:183], v[68:71]
    ds_read_b64_tr_b16 v[164:165], v24 offset:15392
    ds_read_b64_tr_b16 v[166:167], v24 offset:19232
    v_mfma_f32_16x16x32_bf16 v[72:75], v[144:147], v[184:187], v[72:75]
    ds_read_b64_tr_b16 v[168:169], v24 offset:15424
    ds_read_b64_tr_b16 v[170:171], v24 offset:19264
    s_add_u32 m0, s47, 0x14000
    s_nop 0
    buffer_load_dwordx4 v40, s[40:43], s60 offen offset:0 lds
    v_mfma_f32_16x16x32_bf16 v[76:79], v[144:147], v[188:191], v[76:79]
    ds_read_b64_tr_b16 v[172:173], v24 offset:15456
    ds_read_b64_tr_b16 v[174:175], v24 offset:19296
    v_mfma_f32_16x16x32_bf16 v[80:83], v[144:147], v[192:195], v[80:83]
    ds_read_b128 v[196:199], v20 offset:0
    ds_read_b128 v[200:203], v20 offset:2048
    v_mfma_f32_16x16x32_bf16 v[84:87], v[148:151], v[176:179], v[84:87]
    ds_read_b128 v[204:207], v20 offset:4096
    ds_read_b128 v[208:211], v20 offset:6144
    v_mfma_f32_16x16x32_bf16 v[88:91], v[148:151], v[180:183], v[88:91]
    ds_read_b128 v[212:215], v20 offset:8192
    buffer_load_dwordx4 v41, s[40:43], s60 offen offset:1024 lds
    v_mfma_f32_16x16x32_bf16 v[92:95], v[148:151], v[184:187], v[92:95]
    v_mfma_f32_16x16x32_bf16 v[96:99], v[148:151], v[188:191], v[96:99]
    v_mfma_f32_16x16x32_bf16 v[100:103], v[148:151], v[192:195], v[100:103]
    v_mfma_f32_16x16x32_bf16 v[104:107], v[152:155], v[176:179], v[104:107]
    buffer_load_dwordx4 v42, s[40:43], s60 offen offset:2048 lds
    v_mfma_f32_16x16x32_bf16 v[108:111], v[152:155], v[180:183], v[108:111]
    v_mfma_f32_16x16x32_bf16 v[112:115], v[152:155], v[184:187], v[112:115]
    v_mfma_f32_16x16x32_bf16 v[116:119], v[152:155], v[188:191], v[116:119]
    v_mfma_f32_16x16x32_bf16 v[120:123], v[152:155], v[192:195], v[120:123]
    buffer_load_dwordx4 v43, s[40:43], s60 offen offset:3072 lds
    v_mfma_f32_16x16x32_bf16 v[124:127], v[156:159], v[176:179], v[124:127]
    v_mfma_f32_16x16x32_bf16 v[128:131], v[156:159], v[180:183], v[128:131]
    v_mfma_f32_16x16x32_bf16 v[132:135], v[156:159], v[184:187], v[132:135]
    v_mfma_f32_16x16x32_bf16 v[136:139], v[156:159], v[188:191], v[136:139]
    s_add_u32 m0, s47, 0x15000
    s_nop 0
    buffer_load_dwordx4 v44, s[40:43], s60 offen offset:0 lds
    s_add_u32 s60, s60, 0xa000
    s_cmp_ge_u32 s60, s61
    s_cselect_b32 s3, 0x32000, 0
    s_sub_u32 s60, s60, s3
    v_mfma_f32_16x16x32_bf16 v[140:143], v[156:159], v[192:195], v[140:143]
    s_cmp_lg_u32 s44, 2
    s_cbranch_scc1 L_a_ns14
    v_mfma_f32_16x16x32_bf16 v[216:219], v[36:39], v[176:179], v[216:219]
    v_mfma_f32_16x16x32_bf16 v[220:223], v[176:179], v[176:179], v[220:223]
    v_mfma_f32_16x16x32_bf16 v[224:227], v[36:39], v[180:183], v[224:227]
    v_mfma_f32_16x16x32_bf16 v[228:231], v[180:183], v[180:183], v[228:231]
    v_mfma_f32_16x16x32_bf16 v[232:235], v[36:39], v[184:187], v[232:235]
    v_mfma_f32_16x16x32_bf16 v[236:239], v[184:187], v[184:187], v[236:239]
    v_mfma_f32_16x16x32_bf16 v[240:243], v[36:39], v[188:191], v[240:243]
    v_mfma_f32_16x16x32_bf16 v[244:247], v[188:191], v[188:191], v[244:247]
    v_mfma_f32_16x16x32_bf16 v[248:251], v[36:39], v[192:195], v[248:251]
    v_mfma_f32_16x16x32_bf16 v[252:255], v[192:195], v[192:195], v[252:255]
L_a_ns14:
    s_waitcnt lgkmcnt(0)
    v_mfma_f32_16x16x32_bf16 v[64:67], v[160:163], v[196:199], v[64:67]
    v_mfma_f32_16x16x32_bf16 v[68:71], v[160:163], v[200:203], v[68:71]
    v_mfma_f32_16x16x32_bf16 v[72:75], v[160:163], v[204:207], v[72:75]
    v_mfma_f32_16x16x32_bf16 v[76:79], v[160:163], v[208:211], v[76:79]
    v_mfma_f32_16x16x32_bf16 v[80:83], v[160:163], v[212:215], v[80:83]
    v_mfma_f32_16x16x32_bf16 v[84:87], v[164:167], v[196:199], v[84:87]
    s_waitcnt vmcnt(15)
    s_barrier
    ds_read_b64_tr_b16 v[144:145], v25 offset:0
    ds_read_b64_tr_b16 v[146:147], v25 offset:3840
    ds_read_b64_tr_b16 v[148:149], v25 offset:32
    ds_read_b64_tr_b16 v[150:151], v25 offset:3872
    ds_read_b64_tr_b16 v[152:153], v25 offset:64
    ds_read_b64_tr_b16 v[154:155], v25 offset:3904
    ds_read_b64_tr_b16 v[156:157], v25 offset:96
    ds_read_b64_tr_b16 v[158:159], v25 offset:3936
    ds_read_b128 v[176:179], v21 offset:0
    ds_read_b128 v[180:183], v21 offset:2048
    ds_read_b128 v[184:187], v21 offset:4096
    ds_read_b128 v[188:191], v21 offset:6144
    ds_read_b128 v[192:195], v21 offset:8192
    v_mfma_f32_16x16x32_bf16 v[88:91], v[164:167], v[200:203], v[88:91]
    v_mfma_f32_16x16x32_bf16 v[92:95], v[164:167], v[204:207], v[92:95]
    v_mfma_f32_16x16x32_bf16 v[96:99], v[164:167], v[208:211], v[96:99]
    s_add_u32 m0, s47, 0x0
    s_nop 0
    buffer_load_dwordx4 v40, s[40:43], s60 offen offset:0 lds
    v_mfma_f32_16x16x32_bf16 v[100:103], v[164:167], v[212:215], v[100:103]
    v_mfma_f32_16x16x32_bf16 v[104:107], v[168:171], v[196:199], v[104:107]
    v_mfma_f32_16x16x32_bf16 v[108:111], v[168:171], v[200:203], v[108:111]
    buffer_load_dwordx4 v41, s[40:43], s60 offen offset:1024 lds
    v_mfma_f32_16x16x32_bf16 v[112:115], v[168:171], v[204:207], v[112:115]
    v_mfma_f32_16x16x32_bf16 v[116:119], v[168:171], v[208:211], v[116:119]
    v_mfma_f32_16x16x32_bf16 v[120:123], v[168:171], v[212:215], v[120:123]
    buffer_load_dwordx4 v42, s[40:43], s60 offen offset:2048 lds
    v_mfma_f32_16x16x32_bf16 v[124:127], v[172:175], v[196:199], v[124:127]
    v_mfma_f32_16x16x32_bf16 v[128:131], v[172:175], v[200:203], v[128:131]
    buffer_load_dwordx4 v43, s[40:43], s60 offen offset:3072 lds
    v_mfma_f32_16x16x32_bf16 v[132:135], v[172:175], v[204:207], v[132:135]
    v_mfma_f32_16x16x32_bf16 v[136:139], v[172:175], v[208:211], v[136:139]
    s_add_u32 m0, s47, 0x1000
    s_nop 0
    buffer_load_dwordx4 v44, s[40:43], s60 offen offset:0 lds
    s_add_u32 s60, s60, 0xa000
    s_cmp_ge_u32 s60, s61
    s_cselect_b32 s3, 0x32000, 0
    s_sub_u32 s60, s60, s3
    v_mfma_f32_16x16x32_bf16 v[140:143], v[172:175], v[212:215], v[140:143]
    s_cmp_lg_u32 s44, 3
    s_cbranch_scc1 L_a_ns15
    v_mfma_f32_16x16x32_bf16 v[216:219], v[36:39], v[196:199], v[216:219]
    v_mfma_f32_16x16x32_bf16 v[220:223], v[196:199], v[196:199], v[220:223]
    v_mfma_f32_16x16x32_bf16 v[224:227], v[36:39], v[200:203], v[224:227]
    v_mfma_f32_16x16x32_bf16 v[228:231], v[200:203], v[200:203], v[228:231]
    v_mfma_f32_16x16x32_bf16 v[232:235], v[36:39], v[204:207], v[232:235]
    v_mfma_f32_16x16x32_bf16 v[236:239], v[204:207], v[204:207], v[236:239]
    v_mfma_f32_16x16x32_bf16 v[240:243], v[36:39], v[208:211], v[240:243]
    v_mfma_f32_16x16x32_bf16 v[244:247], v[208:211], v[208:211], v[244:247]
    v_mfma_f32_16x16x32_bf16 v[248:251], v[36:39], v[212:215], v[248:251]
    v_mfma_f32_16x16x32_bf16 v[252:255], v[212:215], v[212:215], v[252:255]
L_a_ns15:
    s_waitcnt lgkmcnt(0)
    v_mfma_f32_16x16x32_bf16 v[64:67], v[144:147], v[176:179], v[64:67]
    ds_read_b64_tr_b16 v[160:161], v25 offset:15360
    ds_read_b64_tr_b16 v[162:163], v25 offset:19200
    v_mfma_f32_16x16x32_bf16 v[68:71], v[144:147], v[180:183], v[68:71]
    ds_read_b64_tr_b16 v[164:165], v25 offset:15392
    ds_read_b64_tr_b16 v[166:167], v25 offset:19232
    v_mfma_f32_16x16x32_bf16 v[72:75], v[144:147], v[184:187], v[72:75]
    ds_read_b64_tr_b16 v[168:169], v25 offset:15424
    ds_read_b64_tr_b16 v[170:171], v25 offset:19264
    v_mfma_f32_16x16x32_bf16 v[76:79], v[144:147], v[188:191], v[76:79]
    ds_read_b64_tr_b16 v[172:173], v25 offset:15456
    ds_read_b64_tr_b16 v[174:175], v25 offset:19296
    v_mfma_f32_16x16x32_bf16 v[80:83], v[144:147], v[192:195], v[80:83]
    ds_read_b128 v[196:199], v22 offset:0
    ds_read_b128 v[200:203], v22 offset:2048
    v_mfma_f32_16x16x32_bf16 v[84:87], v[148:151], v[176:179], v[84:87]
    ds_read_b128 v[204:207], v22 offset:4096
    ds_read_b128 v[208:211], v22 offset:6144
    v_mfma_f32_16x16x32_bf16 v[88:91], v[148:151], v[180:183], v[88:91]
    ds_read_b128 v[212:215], v22 offset:8192
    v_mfma_f32_16x16x32_bf16 v[92:95], v[148:151], v[184:187], v[92:95]
    v_mfma_f32_16x16x32_bf16 v[96:99], v[148:151], v[188:191], v[96:99]
    v_mfma_f32_16x16x32_bf16 v[100:103], v[148:151], v[192:195], v[100:103]
    v_mfma_f32_16x16x32_bf16 v[104:107], v[152:155], v[176:179], v[104:107]
    v_mfma_f32_16x16x32_bf16 v[108:111], v[152:155], v[180:183], v[108:111]
    v_mfma_f32_16x16x32_bf16 v[112:115], v[152:155], v[184:187], v[112:115]
    v_mfma_f32_16x16x32_bf16 v[116:119], v[152:155], v[188:191], v[116:119]
    v_mfma_f32_16x16x32_bf16 v[120:123], v[152:155], v[192:195], v[120:123]
    v_mfma_f32_16x16x32_bf16 v[124:127], v[156:159], v[176:179], v[124:127]
    v_mfma_f32_16x16x32_bf16 v[128:131], v[156:159], v[180:183], v[128:131]
    v_mfma_f32_16x16x32_bf16 v[132:135], v[156:159], v[184:187], v[132:135]
    v_mfma_f32_16x16x32_bf16 v[136:139], v[156:159], v[188:191], v[136:139]
    v_mfma_f32_16x16x32_bf16 v[140:143], v[156:159], v[192:195], v[140:143]
    s_cmp_lg_u32 s44, 0
    s_cbranch_scc1 L_a_ns16
    v_mfma_f32_16x16x32_bf16 v[216:219], v[36:39], v[176:179], v[216:219]
    v_mfma_f32_16x16x32_bf16 v[220:223], v[176:179], v[176:179], v[220:223]
    v_mfma_f32_16x16x32_bf16 v[224:227], v[36:39], v[180:183], v[224:227]
    v_mfma_f32_16x16x32_bf16 v[228:231], v[180:183], v[180:183], v[228:231]
    v_mfma_f32_16x16x32_bf16 v[232:235], v[36:39], v[184:187], v[232:235]
    v_mfma_f32_16x16x32_bf16 v[236:239], v[184:187], v[184:187], v[236:239]
    v_mfma_f32_16x16x32_bf16 v[240:243], v[36:39], v[188:191], v[240:243]
    v_mfma_f32_16x16x32_bf16 v[244:247], v[188:191], v[188:191], v[244:247]
    v_mfma_f32_16x16x32_bf16 v[248:251], v[36:39], v[192:195], v[248:251]
    v_mfma_f32_16x16x32_bf16 v[252:255], v[192:195], v[192:195], v[252:255]
L_a_ns16:
    s_waitcnt lgkmcnt(0)
    v_mfma_f32_16x16x32_bf16 v[64:67], v[160:163], v[196:199], v[64:67]
    v_mfma_f32_16x16x32_bf16 v[68:71], v[160:163], v[200:203], v[68:71]
    v_mfma_f32_16x16x32_bf16 v[72:75], v[160:163], v[204:207], v[72:75]
    v_mfma_f32_16x16x32_bf16 v[76:79], v[160:163], v[208:211], v[76:79]
    v_mfma_f32_16x16x32_bf16 v[80:83], v[160:163], v[212:215], v[80:83]
    v_mfma_f32_16x16x32_bf16 v[84:87], v[164:167], v[196:199], v[84:87]
    s_waitcnt vmcnt(10)
    s_barrier
    ds_read_b64_tr_b16 v[144:145], v23 offset:0
    ds_read_b64_tr_b16 v[146:147], v23 offset:3840
    ds_read_b64_tr_b16 v[148:149], v23 offset:32
    ds_read_b64_tr_b16 v[150:151], v23 offset:3872
    ds_read_b64_tr_b16 v[152:153], v23 offset:64
    ds_read_b64_tr_b16 v[154:155], v23 offset:3904
    ds_read_b64_tr_b16 v[156:157], v23 offset:96
    ds_read_b64_tr_b16 v[158:159], v23 offset:3936
    ds_read_b128 v[176:179], v17 offset:0
    ds_read_b128 v[180:183], v17 offset:2048
    ds_read_b128 v[184:187], v17 offset:4096
    ds_read_b128 v[188:191], v17 offset:6144
    ds_read_b128 v[192:195], v17 offset:8192
    v_mfma_f32_16x16x32_bf16 v[88:91], v[164:167], v[200:203], v[88:91]
    v_mfma_f32_16x16x32_bf16 v[92:95], v[164:167], v[204:207], v[92:95]
    v_mfma_f32_16x16x32_bf16 v[96:99], v[164:167], v[208:211], v[96:99]
    s_add_u32 m0, s47, 0x5000
    s_nop 0
    buffer_load_dwordx4 v40, s[40:43], s60 offen offset:0 lds
    v_mfma_f32_16x16x32_bf16 v[100:103], v[164:167], v[212:215], v[100:103]
    v_mfma_f32_16x16x32_bf16 v[104:107], v[168:171], v[196:199], v[104:107]
    v_mfma_f32_16x16x32_bf16 v[108:111], v[168:171], v[200:203], v[108:111]
    buffer_load_dwordx4 v41, s[40:43], s60 offen offset:1024 lds
    v_mfma_f32_16x16x32_bf16 v[112:115], v[168:171], v[204:207], v[112:115]
    v_mfma_f32_16x16x32_bf16 v[116:119], v[168:171], v[208:211], v[116:119]
    v_mfma_f32_16x16x32_bf16 v[120:123], v[168:171], v[212:215], v[120:123]
    buffer_load_dwordx4 v42, s[40:43], s60 offen offset:2048 lds
    v_mfma_f32_16x16x32_bf16 v[124:127], v[172:175], v[196:199], v[124:127]
    v_mfma_f32_16x16x32_bf16 v[128:131], v[172:175], v[200:203], v[128:131]
    buffer_load_dwordx4 v43, s[40:43], s60 offen offset:3072 lds
    v_mfma_f32_16x16x32_bf16 v[132:135], v[172:175], v[204:207], v[132:135]
    v_mfma_f32_16x16x32_bf16 v[136:139], v[172:175], v[208:211], v[136:139]
    s_add_u32 m0, s47, 0x6000
    s_nop 0
    buffer_load_dwordx4 v44, s[40:43], s60 offen offset:0 lds
    s_add_u32 s60, s60, 0xa000
    s_cmp_ge_u32 s60, s61
    s_cselect_b32 s3, 0x32000, 0
    s_sub_u32 s60, s60, s3
    v_mfma_f32_16x16x32_bf16 v[140:143], v[172:175], v[212:215], v[140:143]
    s_cmp_lg_u32 s44, 1
    s_cbranch_scc1 L_a_ns17
    v_mfma_f32_16x16x32_bf16 v[216:219], v[36:39], v[196:199], v[216:219]
    v_mfma_f32_16x16x32_bf16 v[220:223], v[196:199], v[196:199], v[220:223]
    v_mfma_f32_16x16x32_bf16 v[224:227], v[36:39], v[200:203], v[224:227]
    v_mfma_f32_16x16x32_bf16 v[228:231], v[200:203], v[200:203], v[228:231]
    v_mfma_f32_16x16x32_bf16 v[232:235], v[36:39], v[204:207], v[232:235]
    v_mfma_f32_16x16x32_bf16 v[236:239], v[204:207], v[204:207], v[236:239]
    v_mfma_f32_16x16x32_bf16 v[240:243], v[36:39], v[208:211], v[240:243]
    v_mfma_f32_16x16x32_bf16 v[244:247], v[208:211], v[208:211], v[244:247]
    v_mfma_f32_16x16x32_bf16 v[248:251], v[36:39], v[212:215], v[248:251]
    v_mfma_f32_16x16x32_bf16 v[252:255], v[212:215], v[212:215], v[252:255]
L_a_ns17:
    s_waitcnt lgkmcnt(0)
    v_mfma_f32_16x16x32_bf16 v[64:67], v[144:147], v[176:179], v[64:67]
    ds_read_b64_tr_b16 v[160:161], v23 offset:15360
    ds_read_b64_tr_b16 v[162:163], v23 offset:19200
    v_mfma_f32_16x16x32_bf16 v[68:71], v[144:147], v[180:183], v[68:71]
    ds_read_b64_tr_b16 v[164:165], v23 offset:15392
    ds_read_b64_tr_b16 v[166:167], v23 offset:19232
    v_mfma_f32_16x16x32_bf16 v[72:75], v[144:147], v[184:187], v[72:75]
    ds_read_b64_tr_b16 v[168:169], v23 offset:15424
    ds_read_b64_tr_b16 v[170:171], v23 offset:19264
    s_add_u32 m0, s47, 0xa000
    s_nop 0
    buffer_load_dwordx4 v40, s[40:43], s60 offen offset:0 lds
    v_mfma_f32_16x16x32_bf16 v[76:79], v[144:147], v[188:191], v[76:79]
    ds_read_b64_tr_b16 v[172:173], v23 offset:15456
    ds_read_b64_tr_b16 v[174:175], v23 offset:19296
    v_mfma_f32_16x16x32_bf16 v[80:83], v[144:147], v[192:195], v[80:83]
    ds_read_b128 v[196:199], v18 offset:0
    ds_read_b128 v[200:203], v18 offset:2048
    v_mfma_f32_16x16x32_bf16 v[84:87], v[148:151], v[176:179], v[84:87]
    ds_read_b128 v[204:207], v18 offset:4096
    ds_read_b128 v[208:211], v18 offset:6144
    v_mfma_f32_16x16x32_bf16 v[88:91], v[148:151], v[180:183], v[88:91]
    ds_read_b128 v[212:215], v18 offset:8192
    buffer_load_dwordx4 v41, s[40:43], s60 offen offset:1024 lds
    v_mfma_f32_16x16x32_bf16 v[92:95], v[148:151], v[184:187], v[92:95]
    v_mfma_f32_16x16x32_bf16 v[96:99], v[148:151], v[188:191], v[96:99]
    v_mfma_f32_16x16x32_bf16 v[100:103], v[148:151], v[192:195], v[100:103]
    v_mfma_f32_16x16x32_bf16 v[104:107], v[152:155], v[176:179], v[104:107]
    buffer_load_dwordx4 v42, s[40:43], s60 offen offset:2048 lds
    v_mfma_f32_16x16x32_bf16 v[108:111], v[152:155], v[180:183], v[108:111]
    v_mfma_f32_16x16x32_bf16 v[112:115], v[152:155], v[184:187], v[112:115]
    v_mfma_f32_16x16x32_bf16 v[116:119], v[152:155], v[188:191], v[116:119]
    v_mfma_f32_16x16x32_bf16 v[120:123], v[152:155], v[192:195], v[120:123]
    buffer_load_dwordx4 v43, s[40:43], s60 offen offset:3072 lds
    v_mfma_f32_16x16x32_bf16 v[124:127], v[156:159], v[176:179], v[124:127]
    v_mfma_f32_16x16x32_bf16 v[128:131], v[156:159], v[180:183], v[128:131]
    v_mfma_f32_16x16x32_bf16 v[132:135], v[156:159], v[184:187], v[132:135]
    v_mfma_f32_16x16x32_bf16 v[136:139], v[156:159], v[188:191], v[136:139]
    s_add_u32 m0, s47, 0xb000
    s_nop 0
    buffer_load_dwordx4 v44, s[40:43], s60 offen offset:0 lds
    s_add_u32 s60, s60, 0xa000
    s_cmp_ge_u32 s60, s61
    s_cselect_b32 s3, 0x32000, 0
    s_sub_u32 s60, s60, s3
    v_mfma_f32_16x16x32_bf16 v[140:143], v[156:159], v[192:195], v[140:143]
    s_cmp_lg_u32 s44, 2
    s_cbranch_scc1 L_a_ns18
    v_mfma_f32_16x16x32_bf16 v[216:219], v[36:39], v[176:179], v[216:219]
    v_mfma_f32_16x16x32_bf16 v[220:223], v[176:179], v[176:179], v[220:223]
    v_mfma_f32_16x16x32_bf16 v[224:227], v[36:39], v[180:183], v[224:227]
    v_mfma_f32_16x16x32_bf16 v[228:231], v[180:183], v[180:183], v[228:231]
    v_mfma_f32_16x16x32_bf16 v[232:235], v[36:39], v[184:187], v[232:235]
    v_mfma_f32_16x16x32_bf16 v[236:239], v[184:187], v[184:187], v[236:239]
    v_mfma_f32_16x16x32_bf16 v[240:243], v[36:39], v[188:191], v[240:243]
    v_mfma_f32_16x16x32_bf16 v[244:247], v[188:191], v[188:191], v[244:247]
    v_mfma_f32_16x16x32_bf16 v[248:251], v[36:39], v[192:195], v[248:251]
    v_mfma_f32_16x16x32_bf16 v[252:255], v[192:195], v[192:195], v[252:255]
L_a_ns18:
    s_waitcnt lgkmcnt(0)
    v_mfma_f32_16x16x32_bf16 v[64:67], v[160:163], v[196:199], v[64:67]
    v_mfma_f32_16x16x32_bf16 v[68:71], v[160:163], v[200:203], v[68:71]
    v_mfma_f32_16x16x32_bf16 v[72:75], v[160:163], v[204:207], v[72:75]
    v_mfma_f32_16x16x32_bf16 v[76:79], v[160:163], v[208:211], v[76:79]
    v_mfma_f32_16x16x32_bf16 v[80:83], v[160:163], v[212:215], v[80:83]
    v_mfma_f32_16x16x32_bf16 v[84:87], v[164:167], v[196:199], v[84:87]
    v_mfma_f32_16x16x32_bf16 v[88:91], v[164:167], v[200:203], v[88:91]
    v_mfma_f32_16x16x32_bf16 v[92:95], v[164:167], v[204:207], v[92:95]
    v_mfma_f32_16x16x32_bf16 v[96:99], v[164:167], v[208:211], v[96:99]
    s_add_u32 m0, s47, 0xf000
    s_nop 0
    buffer_load_dwordx4 v40, s[40:43], s60 offen offset:0 lds
    v_mfma_f32_16x16x32_bf16 v[100:103], v[164:167], v[212:215], v[100:103]
    v_mfma_f32_16x16x32_bf16 v[104:107], v[168:171], v[196:199], v[104:107]
    v_mfma_f32_16x16x32_bf16 v[108:111], v[168:171], v[200:203], v[108:111]
    buffer_load_dwordx4 v41, s[40:43], s60 offen offset:1024 lds
    v_mfma_f32_16x16x32_bf16 v[112:115], v[168:171], v[204:207], v[112:115]
    v_mfma_f32_16x16x32_bf16 v[116:119], v[168:171], v[208:211], v[116:119]
    v_mfma_f32_16x16x32_bf16 v[120:123], v[168:171], v[212:215], v[120:123]
    buffer_load_dwordx4 v42, s[40:43], s60 offen offset:2048 lds
    v_mfma_f32_16x16x32_bf16 v[124:127], v[172:175], v[196:199], v[124:127]
    v_mfma_f32_16x16x32_bf16 v[128:131], v[172:175], v[200:203], v[128:131]
    buffer_load_dwordx4 v43, s[40:43], s60 offen offset:3072 lds
    v_mfma_f32_16x16x32_bf16 v[132:135], v[172:175], v[204:207], v[132:135]
    v_mfma_f32_16x16x32_bf16 v[136:139], v[172:175], v[208:211], v[136:139]
    s_add_u32 m0, s47, 0x10000
    s_nop 0
    buffer_load_dwordx4 v44, s[40:43], s60 offen offset:0 lds
    s_add_u32 s60, s60, 0xa000
    s_cmp_ge_u32 s60, s61
    s_cselect_b32 s3, 0x32000, 0
    s_sub_u32 s60, s60, s3
    v_mfma_f32_16x16x32_bf16 v[140:143], v[172:175], v[212:215], v[140:143]
    s_cmp_lg_u32 s44, 3
    s_cbranch_scc1 L_a_ns19
    v_mfma_f32_16x16x32_bf16 v[216:219], v[36:39], v[196:199], v[216:219]
    v_mfma_f32_16x16x32_bf16 v[220:223], v[196:199], v[196:199], v[220:223]
    v_mfma_f32_16x16x32_bf16 v[224:227], v[36:39], v[200:203], v[224:227]
    v_mfma_f32_16x16x32_bf16 v[228:231], v[200:203], v[200:203], v[228:231]
    v_mfma_f32_16x16x32_bf16 v[232:235], v[36:39], v[204:207], v[232:235]
    v_mfma_f32_16x16x32_bf16 v[236:239], v[204:207], v[204:207], v[236:239]
    v_mfma_f32_16x16x32_bf16 v[240:243], v[36:39], v[208:211], v[240:243]
    v_mfma_f32_16x16x32_bf16 v[244:247], v[208:211], v[208:211], v[244:247]
    v_mfma_f32_16x16x32_bf16 v[248:251], v[36:39], v[212:215], v[248:251]
    v_mfma_f32_16x16x32_bf16 v[252:255], v[212:215], v[212:215], v[252:255]
L_a_ns19:
    v_and_b32 v2, 3, v7
    v_cmp_eq_u32 vcc, 1, v2
    v_cmp_eq_u32 s[62:63], 2, v2
    v_cmp_eq_u32 s[64:65], 3, v2
    v_lshrrev_b32 v3, 2, v7
    v_cmp_eq_u32 s[66:67], v3, v6
    s_mul_i32 s49, s44, 640
    s_add_u32 s49, s49, 160000
    v_lshl_add_u32 v2, v7, 3, s49

    v_cndmask_b32 v217, v220, v221, vcc
    v_cndmask_b32 v217, v217, v222, s[62:63]
    v_cndmask_b32 v217, v217, v223, s[64:65]

    v_cndmask_b32 v225, v228, v229, vcc
    v_cndmask_b32 v225, v225, v230, s[62:63]
    v_cndmask_b32 v225, v225, v231, s[64:65]

    v_cndmask_b32 v233, v236, v237, vcc
    v_cndmask_b32 v233, v233, v238, s[62:63]
    v_cndmask_b32 v233, v233, v239, s[64:65]

    v_cndmask_b32 v241, v244, v245, vcc
    v_cndmask_b32 v241, v241, v246, s[62:63]
    v_cndmask_b32 v241, v241, v247, s[64:65]

    v_cndmask_b32 v249, v252, v253, vcc
    v_cndmask_b32 v249, v249, v254, s[62:63]
    v_cndmask_b32 v249, v249, v255, s[64:65]

    s_mov_b64 exec, s[66:67]
    ds_write_b64 v2, v[216:217] offset:0
    ds_write_b64 v2, v[224:225] offset:128
    ds_write_b64 v2, v[232:233] offset:256
    ds_write_b64 v2, v[240:241] offset:384
    ds_write_b64 v2, v[248:249] offset:512
    s_mov_b64 exec, -1
    v_lshlrev_b32 v2, 3, v7
    v_add_u32 v2, 160000, v2

    v_mov_b32_dpp v192, v64 row_newbcast:0 row_mask:0xf bank_mask:0xf
    v_mov_b32_dpp v193, v65 row_newbcast:0 row_mask:0xf bank_mask:0xf
    v_mov_b32_dpp v194, v66 row_newbcast:0 row_mask:0xf bank_mask:0xf
    v_mov_b32_dpp v195, v67 row_newbcast:0 row_mask:0xf bank_mask:0xf
    v_mov_b32_dpp v196, v84 row_newbcast:0 row_mask:0xf bank_mask:0xf
    v_mov_b32_dpp v197, v85 row_newbcast:0 row_mask:0xf bank_mask:0xf
    v_mov_b32_dpp v198, v86 row_newbcast:0 row_mask:0xf bank_mask:0xf
    v_mov_b32_dpp v199, v87 row_newbcast:0 row_mask:0xf bank_mask:0xf
    v_mov_b32_dpp v200, v104 row_newbcast:0 row_mask:0xf bank_mask:0xf
    v_mov_b32_dpp v201, v105 row_newbcast:0 row_mask:0xf bank_mask:0xf
    v_mov_b32_dpp v202, v106 row_newbcast:0 row_mask:0xf bank_mask:0xf
    v_mov_b32_dpp v203, v107 row_newbcast:0 row_mask:0xf bank_mask:0xf
    v_mov_b32_dpp v204, v124 row_newbcast:0 row_mask:0xf bank_mask:0xf
    v_mov_b32_dpp v205, v125 row_newbcast:0 row_mask:0xf bank_mask:0xf
    v_mov_b32_dpp v206, v126 row_newbcast:0 row_mask:0xf bank_mask:0xf
    v_mov_b32_dpp v207, v127 row_newbcast:0 row_mask:0xf bank_mask:0xf
    s_waitcnt lgkmcnt(0)
    s_barrier
    ds_read_b64 v[144:145], v2 offset:0
    ds_read_b64 v[146:147], v2 offset:640
    ds_read_b64 v[148:149], v2 offset:1280
    ds_read_b64 v[150:151], v2 offset:1920
    ds_read_b64 v[152:153], v2 offset:128
    ds_read_b64 v[154:155], v2 offset:768
    ds_read_b64 v[156:157], v2 offset:1408
    ds_read_b64 v[158:159], v2 offset:2048
    ds_read_b64 v[160:161], v2 offset:256
    ds_read_b64 v[162:163], v2 offset:896
    ds_read_b64 v[164:165], v2 offset:1536
    ds_read_b64 v[166:167], v2 offset:2176
    ds_read_b64 v[168:169], v2 offset:384
    ds_read_b64 v[170:171], v2 offset:1024
    ds_read_b64 v[172:173], v2 offset:1664
    ds_read_b64 v[174:175], v2 offset:2304
    ds_read_b64 v[176:177], v2 offset:512
    ds_read_b64 v[178:179], v2 offset:1152
    ds_read_b64 v[180:181], v2 offset:1792
    ds_read_b64 v[182:183], v2 offset:2432
    v_mov_b32 v241, 0
    buffer_load_dword v254, v241, s[32:35], 0 offen sc1
    s_mov_b32 s28, s12
    s_mov_b32 s29, s13
    s_mov_b32 s30, 0x600000
    s_mov_b32 s31, 0x00020000
    s_lshl_b32 s49, s51, 8
    s_add_u32 s49, s49, 0
    v_add_u32 v240, s49, v0
    v_mul_u32_u24 v241, 10923, v240
    v_lshrrev_b32 v241, 16, v241
    v_mul_u32_u24 v242, 6, v241
    v_sub_u32 v242, v240, v242
    v_mul_u32_u24 v241, 3072, v241
    v_lshl_add_u32 v240, v242, 7, v241
    s_lshr_b32 s49, s50, 1
    s_mul_i32 s49, s49, 768

    buffer_load_dword v252, v240, s[28:31], s49 offen
    s_lshl_b32 s49, s51, 8
    s_add_u32 s49, s49, 8192
    v_add_u32 v240, s49, v0
    v_mul_u32_u24 v241, 10923, v240
    v_lshrrev_b32 v241, 16, v241
    v_mul_u32_u24 v242, 6, v241
    v_sub_u32 v242, v240, v242
    v_mul_u32_u24 v241, 3072, v241
    v_lshl_add_u32 v240, v242, 7, v241
    s_lshr_b32 s49, s50, 1
    s_mul_i32 s49, s49, 768

    buffer_load_dword v253, v240, s[28:31], s49 offen
    v_bfe_u32 v240, v1, 2, 3
    v_bfe_u32 v241, v1, 5, 1
    v_lshl_or_b32 v240, v241, 4, v240
    v_and_b32 v241, 3, v1
    v_lshlrev_b32 v241, 3, v241
    v_mul_u32_u24 v240, 160, v240
    v_add3_u32 v240, v240, v241, s47
    v_add_u32 v241, 61440, v240

    s_waitcnt lgkmcnt(15)
    v_pk_add_f32 v[144:145], v[144:145], v[146:147]
    v_pk_add_f32 v[148:149], v[148:149], v[150:151]
    v_pk_add_f32 v[144:145], v[144:145], v[148:149]
    v_mul_f32 v24, 0xbacccccd, v144
    v_mul_f32 v25, 0x3acccccd, v145
    v_fma_f32 v25, -v24, v24, v25
    v_max_f32 v25, 0, v25
    v_add_f32 v25, 0x3727c5ac, v25
    v_rsq_f32 v25, v25

    s_waitcnt lgkmcnt(12)
    v_pk_add_f32 v[152:153], v[152:153], v[154:155]
    v_pk_add_f32 v[156:157], v[156:157], v[158:159]
    v_pk_add_f32 v[152:153], v[152:153], v[156:157]
    v_mul_f32 v28, 0xbacccccd, v152
    v_mul_f32 v29, 0x3acccccd, v153
    v_fma_f32 v29, -v28, v28, v29
    v_max_f32 v29, 0, v29
    v_add_f32 v29, 0x3727c5ac, v29
    v_rsq_f32 v29, v29

    s_waitcnt lgkmcnt(8)
    v_pk_add_f32 v[160:161], v[160:161], v[162:163]
    v_pk_add_f32 v[164:165], v[164:165], v[166:167]
    v_pk_add_f32 v[160:161], v[160:161], v[164:165]
    v_mul_f32 v32, 0xbacccccd, v160
    v_mul_f32 v33, 0x3acccccd, v161
    v_fma_f32 v33, -v32, v32, v33
    v_max_f32 v33, 0, v33
    v_add_f32 v33, 0x3727c5ac, v33
    v_rsq_f32 v33, v33

    s_waitcnt lgkmcnt(4)
    v_pk_add_f32 v[168:169], v[168:169], v[170:171]
    v_pk_add_f32 v[172:173], v[172:173], v[174:175]
    v_pk_add_f32 v[168:169], v[168:169], v[172:173]
    v_mul_f32 v36, 0xbacccccd, v168
    v_mul_f32 v37, 0x3acccccd, v169
    v_fma_f32 v37, -v36, v36, v37
    v_max_f32 v37, 0, v37
    v_add_f32 v37, 0x3727c5ac, v37
    v_rsq_f32 v37, v37

    s_waitcnt lgkmcnt(0)
    v_pk_add_f32 v[176:177], v[176:177], v[178:179]
    v_pk_add_f32 v[180:181], v[180:181], v[182:183]
    v_pk_add_f32 v[176:177], v[176:177], v[180:181]
    v_mul_f32 v40, 0xbacccccd, v176
    v_mul_f32 v41, 0x3acccccd, v177
    v_fma_f32 v41, -v40, v40, v41
    v_max_f32 v41, 0, v41
    v_add_f32 v41, 0x3727c5ac, v41
    v_rsq_f32 v41, v41

    v_mul_u32_u24 v3, 520, v7
    v_lshl_add_u32 v3, v6, 3, v3
    s_lshl_b32 s49, s44, 7
    v_add_u32 v3, s49, v3

    v_pk_fma_f32 v[64:65], v[192:193], v[24:25], v[64:65] op_sel_hi:[1,0,1]
    v_pk_fma_f32 v[66:67], v[194:195], v[24:25], v[66:67] op_sel_hi:[1,0,1]
    v_pk_mul_f32 v[64:65], v[64:65], v[24:25] op_sel:[0,1]
    v_pk_mul_f32 v[66:67], v[66:67], v[24:25] op_sel:[0,1]
    v_cvt_pk_bf16_f32 v64, v64, v65
    v_cvt_pk_bf16_f32 v65, v66, v67
    ds_write_b64 v3, v[64:65] offset:0

    v_pk_fma_f32 v[84:85], v[196:197], v[24:25], v[84:85] op_sel_hi:[1,0,1]
    v_pk_fma_f32 v[86:87], v[198:199], v[24:25], v[86:87] op_sel_hi:[1,0,1]
    v_pk_mul_f32 v[84:85], v[84:85], v[24:25] op_sel:[0,1]
    v_pk_mul_f32 v[86:87], v[86:87], v[24:25] op_sel:[0,1]
    v_cvt_pk_bf16_f32 v84, v84, v85
    v_cvt_pk_bf16_f32 v85, v86, v87
    ds_write_b64 v3, v[84:85] offset:32

    v_pk_fma_f32 v[104:105], v[200:201], v[24:25], v[104:105] op_sel_hi:[1,0,1]
    v_pk_fma_f32 v[106:107], v[202:203], v[24:25], v[106:107] op_sel_hi:[1,0,1]
    v_pk_mul_f32 v[104:105], v[104:105], v[24:25] op_sel:[0,1]
    v_pk_mul_f32 v[106:107], v[106:107], v[24:25] op_sel:[0,1]
    v_cvt_pk_bf16_f32 v104, v104, v105
    v_cvt_pk_bf16_f32 v105, v106, v107
    ds_write_b64 v3, v[104:105] offset:64

    v_pk_fma_f32 v[124:125], v[204:205], v[24:25], v[124:125] op_sel_hi:[1,0,1]
    v_pk_fma_f32 v[126:127], v[206:207], v[24:25], v[126:127] op_sel_hi:[1,0,1]
    v_pk_mul_f32 v[124:125], v[124:125], v[24:25] op_sel:[0,1]
    v_pk_mul_f32 v[126:127], v[126:127], v[24:25] op_sel:[0,1]
    v_cvt_pk_bf16_f32 v124, v124, v125
    v_cvt_pk_bf16_f32 v125, v126, v127
    ds_write_b64 v3, v[124:125] offset:96

    v_pk_fma_f32 v[68:69], v[192:193], v[28:29], v[68:69] op_sel_hi:[1,0,1]
    v_pk_fma_f32 v[70:71], v[194:195], v[28:29], v[70:71] op_sel_hi:[1,0,1]
    v_pk_mul_f32 v[68:69], v[68:69], v[28:29] op_sel:[0,1]
    v_pk_mul_f32 v[70:71], v[70:71], v[28:29] op_sel:[0,1]
    v_cvt_pk_bf16_f32 v68, v68, v69
    v_cvt_pk_bf16_f32 v69, v70, v71
    ds_write_b64 v3, v[68:69] offset:8320

    v_pk_fma_f32 v[88:89], v[196:197], v[28:29], v[88:89] op_sel_hi:[1,0,1]
    v_pk_fma_f32 v[90:91], v[198:199], v[28:29], v[90:91] op_sel_hi:[1,0,1]
    v_pk_mul_f32 v[88:89], v[88:89], v[28:29] op_sel:[0,1]
    v_pk_mul_f32 v[90:91], v[90:91], v[28:29] op_sel:[0,1]
    v_cvt_pk_bf16_f32 v88, v88, v89
    v_cvt_pk_bf16_f32 v89, v90, v91
    ds_write_b64 v3, v[88:89] offset:8352

    v_pk_fma_f32 v[108:109], v[200:201], v[28:29], v[108:109] op_sel_hi:[1,0,1]
    v_pk_fma_f32 v[110:111], v[202:203], v[28:29], v[110:111] op_sel_hi:[1,0,1]
    v_pk_mul_f32 v[108:109], v[108:109], v[28:29] op_sel:[0,1]
    v_pk_mul_f32 v[110:111], v[110:111], v[28:29] op_sel:[0,1]
    v_cvt_pk_bf16_f32 v108, v108, v109
    v_cvt_pk_bf16_f32 v109, v110, v111
    ds_write_b64 v3, v[108:109] offset:8384

    v_pk_fma_f32 v[128:129], v[204:205], v[28:29], v[128:129] op_sel_hi:[1,0,1]
    v_pk_fma_f32 v[130:131], v[206:207], v[28:29], v[130:131] op_sel_hi:[1,0,1]
    v_pk_mul_f32 v[128:129], v[128:129], v[28:29] op_sel:[0,1]
    v_pk_mul_f32 v[130:131], v[130:131], v[28:29] op_sel:[0,1]
    v_cvt_pk_bf16_f32 v128, v128, v129
    v_cvt_pk_bf16_f32 v129, v130, v131
    ds_write_b64 v3, v[128:129] offset:8416

    v_pk_fma_f32 v[72:73], v[192:193], v[32:33], v[72:73] op_sel_hi:[1,0,1]
    v_pk_fma_f32 v[74:75], v[194:195], v[32:33], v[74:75] op_sel_hi:[1,0,1]
    v_pk_mul_f32 v[72:73], v[72:73], v[32:33] op_sel:[0,1]
    v_pk_mul_f32 v[74:75], v[74:75], v[32:33] op_sel:[0,1]
    v_cvt_pk_bf16_f32 v72, v72, v73
    v_cvt_pk_bf16_f32 v73, v74, v75
    ds_write_b64 v3, v[72:73] offset:16640

    v_pk_fma_f32 v[92:93], v[196:197], v[32:33], v[92:93] op_sel_hi:[1,0,1]
    v_pk_fma_f32 v[94:95], v[198:199], v[32:33], v[94:95] op_sel_hi:[1,0,1]
    v_pk_mul_f32 v[92:93], v[92:93], v[32:33] op_sel:[0,1]
    v_pk_mul_f32 v[94:95], v[94:95], v[32:33] op_sel:[0,1]
    v_cvt_pk_bf16_f32 v92, v92, v93
    v_cvt_pk_bf16_f32 v93, v94, v95
    ds_write_b64 v3, v[92:93] offset:16672

    v_pk_fma_f32 v[112:113], v[200:201], v[32:33], v[112:113] op_sel_hi:[1,0,1]
    v_pk_fma_f32 v[114:115], v[202:203], v[32:33], v[114:115] op_sel_hi:[1,0,1]
    v_pk_mul_f32 v[112:113], v[112:113], v[32:33] op_sel:[0,1]
    v_pk_mul_f32 v[114:115], v[114:115], v[32:33] op_sel:[0,1]
    v_cvt_pk_bf16_f32 v112, v112, v113
    v_cvt_pk_bf16_f32 v113, v114, v115
    ds_write_b64 v3, v[112:113] offset:16704

    v_pk_fma_f32 v[132:133], v[204:205], v[32:33], v[132:133] op_sel_hi:[1,0,1]
    v_pk_fma_f32 v[134:135], v[206:207], v[32:33], v[134:135] op_sel_hi:[1,0,1]
    v_pk_mul_f32 v[132:133], v[132:133], v[32:33] op_sel:[0,1]
    v_pk_mul_f32 v[134:135], v[134:135], v[32:33] op_sel:[0,1]
    v_cvt_pk_bf16_f32 v132, v132, v133
    v_cvt_pk_bf16_f32 v133, v134, v135
    ds_write_b64 v3, v[132:133] offset:16736

    v_pk_fma_f32 v[76:77], v[192:193], v[36:37], v[76:77] op_sel_hi:[1,0,1]
    v_pk_fma_f32 v[78:79], v[194:195], v[36:37], v[78:79] op_sel_hi:[1,0,1]
    v_pk_mul_f32 v[76:77], v[76:77], v[36:37] op_sel:[0,1]
    v_pk_mul_f32 v[78:79], v[78:79], v[36:37] op_sel:[0,1]
    v_cvt_pk_bf16_f32 v76, v76, v77
    v_cvt_pk_bf16_f32 v77, v78, v79
    ds_write_b64 v3, v[76:77] offset:24960

    v_pk_fma_f32 v[96:97], v[196:197], v[36:37], v[96:97] op_sel_hi:[1,0,1]
    v_pk_fma_f32 v[98:99], v[198:199], v[36:37], v[98:99] op_sel_hi:[1,0,1]
    v_pk_mul_f32 v[96:97], v[96:97], v[36:37] op_sel:[0,1]
    v_pk_mul_f32 v[98:99], v[98:99], v[36:37] op_sel:[0,1]
    v_cvt_pk_bf16_f32 v96, v96, v97
    v_cvt_pk_bf16_f32 v97, v98, v99
    ds_write_b64 v3, v[96:97] offset:24992

    v_pk_fma_f32 v[116:117], v[200:201], v[36:37], v[116:117] op_sel_hi:[1,0,1]
    v_pk_fma_f32 v[118:119], v[202:203], v[36:37], v[118:119] op_sel_hi:[1,0,1]
    v_pk_mul_f32 v[116:117], v[116:117], v[36:37] op_sel:[0,1]
    v_pk_mul_f32 v[118:119], v[118:119], v[36:37] op_sel:[0,1]
    v_cvt_pk_bf16_f32 v116, v116, v117
    v_cvt_pk_bf16_f32 v117, v118, v119
    ds_write_b64 v3, v[116:117] offset:25024

    v_pk_fma_f32 v[136:137], v[204:205], v[36:37], v[136:137] op_sel_hi:[1,0,1]
    v_pk_fma_f32 v[138:139], v[206:207], v[36:37], v[138:139] op_sel_hi:[1,0,1]
    v_pk_mul_f32 v[136:137], v[136:137], v[36:37] op_sel:[0,1]
    v_pk_mul_f32 v[138:139], v[138:139], v[36:37] op_sel:[0,1]
    v_cvt_pk_bf16_f32 v136, v136, v137
    v_cvt_pk_bf16_f32 v137, v138, v139
    ds_write_b64 v3, v[136:137] offset:25056

    v_pk_fma_f32 v[80:81], v[192:193], v[40:41], v[80:81] op_sel_hi:[1,0,1]
    v_pk_fma_f32 v[82:83], v[194:195], v[40:41], v[82:83] op_sel_hi:[1,0,1]
    v_pk_mul_f32 v[80:81], v[80:81], v[40:41] op_sel:[0,1]
    v_pk_mul_f32 v[82:83], v[82:83], v[40:41] op_sel:[0,1]
    v_cvt_pk_bf16_f32 v80, v80, v81
    v_cvt_pk_bf16_f32 v81, v82, v83
    ds_write_b64 v3, v[80:81] offset:33280

    v_pk_fma_f32 v[100:101], v[196:197], v[40:41], v[100:101] op_sel_hi:[1,0,1]
    v_pk_fma_f32 v[102:103], v[198:199], v[40:41], v[102:103] op_sel_hi:[1,0,1]
    v_pk_mul_f32 v[100:101], v[100:101], v[40:41] op_sel:[0,1]
    v_pk_mul_f32 v[102:103], v[102:103], v[40:41] op_sel:[0,1]
    v_cvt_pk_bf16_f32 v100, v100, v101
    v_cvt_pk_bf16_f32 v101, v102, v103
    ds_write_b64 v3, v[100:101] offset:33312

    v_pk_fma_f32 v[120:121], v[200:201], v[40:41], v[120:121] op_sel_hi:[1,0,1]
    v_pk_fma_f32 v[122:123], v[202:203], v[40:41], v[122:123] op_sel_hi:[1,0,1]
    v_pk_mul_f32 v[120:121], v[120:121], v[40:41] op_sel:[0,1]
    v_pk_mul_f32 v[122:123], v[122:123], v[40:41] op_sel:[0,1]
    v_cvt_pk_bf16_f32 v120, v120, v121
    v_cvt_pk_bf16_f32 v121, v122, v123
    ds_write_b64 v3, v[120:121] offset:33344

    v_pk_fma_f32 v[140:141], v[204:205], v[40:41], v[140:141] op_sel_hi:[1,0,1]
    v_pk_fma_f32 v[142:143], v[206:207], v[40:41], v[142:143] op_sel_hi:[1,0,1]
    v_pk_mul_f32 v[140:141], v[140:141], v[40:41] op_sel:[0,1]
    v_pk_mul_f32 v[142:143], v[142:143], v[40:41] op_sel:[0,1]
    v_cvt_pk_bf16_f32 v140, v140, v141
    v_cvt_pk_bf16_f32 v141, v142, v143
    ds_write_b64 v3, v[140:141] offset:33376

    s_waitcnt vmcnt(3)
    ds_read_b64_tr_b16 a[156:157], v241 offset:20480
    ds_read_b64_tr_b16 a[158:159], v241 offset:21760
    ds_read_b64_tr_b16 a[160:161], v241 offset:20512
    ds_read_b64_tr_b16 a[162:163], v241 offset:21792
    ds_read_b64_tr_b16 a[164:165], v241 offset:20544
    ds_read_b64_tr_b16 a[166:167], v241 offset:21824
    ds_read_b64_tr_b16 a[168:169], v241 offset:20576
    ds_read_b64_tr_b16 a[170:171], v241 offset:21856
    ds_read_b64_tr_b16 a[172:173], v241 offset:20608
    ds_read_b64_tr_b16 a[174:175], v241 offset:21888
    ds_read_b64_tr_b16 a[176:177], v240 offset:0
    ds_read_b64_tr_b16 a[178:179], v240 offset:1280
    ds_read_b64_tr_b16 a[180:181], v240 offset:32
    ds_read_b64_tr_b16 a[182:183], v240 offset:1312
    ds_read_b64_tr_b16 a[184:185], v240 offset:64
    ds_read_b64_tr_b16 a[186:187], v240 offset:1344
    ds_read_b64_tr_b16 a[188:189], v240 offset:96
    ds_read_b64_tr_b16 a[190:191], v240 offset:1376
    ds_read_b64_tr_b16 a[192:193], v240 offset:128
    ds_read_b64_tr_b16 a[194:195], v240 offset:1408
    ds_read_b64_tr_b16 a[196:197], v240 offset:20480
    ds_read_b64_tr_b16 a[198:199], v240 offset:21760
    ds_read_b64_tr_b16 a[200:201], v240 offset:20512
    ds_read_b64_tr_b16 a[202:203], v240 offset:21792
    ds_read_b64_tr_b16 a[204:205], v240 offset:20544
    ds_read_b64_tr_b16 a[206:207], v240 offset:21824
    ds_read_b64_tr_b16 a[208:209], v240 offset:20576
    ds_read_b64_tr_b16 a[210:211], v240 offset:21856
    ds_read_b64_tr_b16 a[212:213], v240 offset:20608
    ds_read_b64_tr_b16 a[214:215], v240 offset:21888
    ds_read_b64_tr_b16 a[216:217], v240 offset:40960
    ds_read_b64_tr_b16 a[218:219], v240 offset:42240
    ds_read_b64_tr_b16 a[220:221], v240 offset:40992
    ds_read_b64_tr_b16 a[222:223], v240 offset:42272
    ds_read_b64_tr_b16 a[224:225], v240 offset:41024
    ds_read_b64_tr_b16 a[226:227], v240 offset:42304
    ds_read_b64_tr_b16 a[228:229], v240 offset:41056
    ds_read_b64_tr_b16 a[230:231], v240 offset:42336
    ds_read_b64_tr_b16 a[232:233], v240 offset:41088
    ds_read_b64_tr_b16 a[234:235], v240 offset:42368
    ds_read_b64_tr_b16 a[236:237], v241 offset:0
    ds_read_b64_tr_b16 a[238:239], v241 offset:1280
    ds_read_b64_tr_b16 a[240:241], v241 offset:32
    ds_read_b64_tr_b16 a[242:243], v241 offset:1312
    ds_read_b64_tr_b16 a[244:245], v241 offset:64
    ds_read_b64_tr_b16 a[246:247], v241 offset:1344
    ds_read_b64_tr_b16 a[248:249], v241 offset:96
    ds_read_b64_tr_b16 a[250:251], v241 offset:1376
    ds_read_b64_tr_b16 a[252:253], v241 offset:128
    ds_read_b64_tr_b16 a[254:255], v241 offset:1408
    s_waitcnt lgkmcnt(0)
    s_barrier
    v_add_u32 v2, 2, v1
    v_mul_u32_u24 v2, 520, v2
    s_mul_i32 s49, s44, 40
    v_add_u32 v2, s49, v2
    s_lshl_b32 s58, s52, 6
    v_add_u32 v3, s58, v1

    ds_read_b64 v[24:25], v2 offset:7280
    ds_read_b64 v[26:27], v2 offset:7288
    ds_read_b64 v[28:29], v2 offset:7296
    ds_read_b64 v[30:31], v2 offset:7304
    ds_read_b64 v[32:33], v2 offset:7312
    ds_read_b64 v[64:65], v2 offset:7440
    ds_read_b64 v[66:67], v2 offset:7448
    ds_read_b64 v[68:69], v2 offset:7456
    ds_read_b64 v[70:71], v2 offset:7464
    ds_read_b64 v[72:73], v2 offset:7472
    ds_read_b64 v[74:75], v2 offset:6400
    ds_read_b64 v[76:77], v2 offset:6408
    ds_read_b64 v[78:79], v2 offset:6416
    ds_read_b64 v[80:81], v2 offset:6424
    ds_read_b64 v[82:83], v2 offset:6432
    v_mov_b32 v34, 0
    v_mov_b32 v35, 0
    v_mov_b32 v36, 0
    v_mov_b32 v37, 0
    v_mov_b32 v38, 0
    v_mov_b32 v39, 0
    v_mov_b32 v40, 0
    v_mov_b32 v41, 0
    v_mov_b32 v42, 0
    v_mov_b32 v43, 0
    v_mov_b32 v44, 0
    v_mov_b32 v45, 0
    v_mov_b32 v46, 0
    v_mov_b32 v47, 0
    v_mov_b32 v48, 0
    v_mov_b32 v49, 0
    v_mov_b32 v50, 0
    v_mov_b32 v51, 0
    v_mov_b32 v52, 0
    v_mov_b32 v53, 0
    v_mov_b32 v54, 0
    v_mov_b32 v55, 0
    v_mov_b32 v56, 0
    v_mov_b32 v57, 0
    v_mov_b32 v58, 0
    v_mov_b32 v59, 0
    v_mov_b32 v60, 0
    v_mov_b32 v61, 0
    v_mov_b32 v62, 0
    v_mov_b32 v63, 0
    ds_read_b64 v[84:85], v2 offset:5360
    ds_read_b64 v[86:87], v2 offset:5368
    ds_read_b64 v[88:89], v2 offset:5376
    ds_read_b64 v[90:91], v2 offset:5384
    ds_read_b64 v[92:93], v2 offset:5392
    s_waitcnt lgkmcnt(10)
    v_dot2c_f32_bf16 v34, v24, v64
    v_dot2c_f32_bf16 v34, v25, v65
    v_dot2c_f32_bf16 v34, v26, v66
    v_dot2c_f32_bf16 v34, v27, v67
    v_dot2c_f32_bf16 v34, v28, v68
    v_dot2c_f32_bf16 v34, v29, v69
    v_dot2c_f32_bf16 v34, v30, v70
    v_dot2c_f32_bf16 v34, v31, v71
    v_dot2c_f32_bf16 v34, v32, v72
    v_dot2c_f32_bf16 v34, v33, v73
    ds_read_b64 v[94:95], v2 offset:4320
    ds_read_b64 v[96:97], v2 offset:4328
    ds_read_b64 v[98:99], v2 offset:4336
    ds_read_b64 v[100:101], v2 offset:4344
    ds_read_b64 v[102:103], v2 offset:4352
    s_waitcnt lgkmcnt(10)
    v_dot2c_f32_bf16 v35, v24, v74
    v_dot2c_f32_bf16 v35, v25, v75
    v_dot2c_f32_bf16 v35, v26, v76
    v_dot2c_f32_bf16 v35, v27, v77
    v_dot2c_f32_bf16 v35, v28, v78
    v_dot2c_f32_bf16 v35, v29, v79
    v_dot2c_f32_bf16 v35, v30, v80
    v_dot2c_f32_bf16 v35, v31, v81
    v_dot2c_f32_bf16 v35, v32, v82
    v_dot2c_f32_bf16 v35, v33, v83
    ds_read_b64 v[104:105], v2 offset:3280
    ds_read_b64 v[106:107], v2 offset:3288
    ds_read_b64 v[108:109], v2 offset:3296
    ds_read_b64 v[110:111], v2 offset:3304
    ds_read_b64 v[112:113], v2 offset:3312
    s_waitcnt lgkmcnt(10)
    v_dot2c_f32_bf16 v36, v24, v84
    v_dot2c_f32_bf16 v36, v25, v85
    v_dot2c_f32_bf16 v36, v26, v86
    v_dot2c_f32_bf16 v36, v27, v87
    v_dot2c_f32_bf16 v36, v28, v88
    v_dot2c_f32_bf16 v36, v29, v89
    v_dot2c_f32_bf16 v36, v30, v90
    v_dot2c_f32_bf16 v36, v31, v91
    v_dot2c_f32_bf16 v36, v32, v92
    v_dot2c_f32_bf16 v36, v33, v93
    ds_read_b64 v[114:115], v2 offset:2240
    ds_read_b64 v[116:117], v2 offset:2248
    ds_read_b64 v[118:119], v2 offset:2256
    ds_read_b64 v[120:121], v2 offset:2264
    ds_read_b64 v[122:123], v2 offset:2272
    s_waitcnt lgkmcnt(10)
    v_dot2c_f32_bf16 v37, v24, v94
    v_dot2c_f32_bf16 v37, v25, v95
    v_dot2c_f32_bf16 v37, v26, v96
    v_dot2c_f32_bf16 v37, v27, v97
    v_dot2c_f32_bf16 v37, v28, v98
    v_dot2c_f32_bf16 v37, v29, v99
    v_dot2c_f32_bf16 v37, v30, v100
    v_dot2c_f32_bf16 v37, v31, v101
    v_dot2c_f32_bf16 v37, v32, v102
    v_dot2c_f32_bf16 v37, v33, v103
    ds_read_b64 v[124:125], v2 offset:1200
    ds_read_b64 v[126:127], v2 offset:1208
    ds_read_b64 v[128:129], v2 offset:1216
    ds_read_b64 v[130:131], v2 offset:1224
    ds_read_b64 v[132:133], v2 offset:1232
    s_waitcnt lgkmcnt(10)
    v_dot2c_f32_bf16 v38, v24, v104
    v_dot2c_f32_bf16 v38, v25, v105
    v_dot2c_f32_bf16 v38, v26, v106
    v_dot2c_f32_bf16 v38, v27, v107
    v_dot2c_f32_bf16 v38, v28, v108
    v_dot2c_f32_bf16 v38, v29, v109
    v_dot2c_f32_bf16 v38, v30, v110
    v_dot2c_f32_bf16 v38, v31, v111
    v_dot2c_f32_bf16 v38, v32, v112
    v_dot2c_f32_bf16 v38, v33, v113
    ds_read_b64 v[134:135], v2 offset:160
    ds_read_b64 v[136:137], v2 offset:168
    ds_read_b64 v[138:139], v2 offset:176
    ds_read_b64 v[140:141], v2 offset:184
    ds_read_b64 v[142:143], v2 offset:192
    s_waitcnt lgkmcnt(10)
    v_dot2c_f32_bf16 v39, v24, v114
    v_dot2c_f32_bf16 v39, v25, v115
    v_dot2c_f32_bf16 v39, v26, v116
    v_dot2c_f32_bf16 v39, v27, v117
    v_dot2c_f32_bf16 v39, v28, v118
    v_dot2c_f32_bf16 v39, v29, v119
    v_dot2c_f32_bf16 v39, v30, v120
    v_dot2c_f32_bf16 v39, v31, v121
    v_dot2c_f32_bf16 v39, v32, v122
    v_dot2c_f32_bf16 v39, v33, v123
    ds_read_b64 v[144:145], v2 offset:7600
    ds_read_b64 v[146:147], v2 offset:7608
    ds_read_b64 v[148:149], v2 offset:7616
    ds_read_b64 v[150:151], v2 offset:7624
    ds_read_b64 v[152:153], v2 offset:7632
    s_waitcnt lgkmcnt(10)
    v_dot2c_f32_bf16 v40, v24, v124
    v_dot2c_f32_bf16 v40, v25, v125
    v_dot2c_f32_bf16 v40, v26, v126
    v_dot2c_f32_bf16 v40, v27, v127
    v_dot2c_f32_bf16 v40, v28, v128
    v_dot2c_f32_bf16 v40, v29, v129
    v_dot2c_f32_bf16 v40, v30, v130
    v_dot2c_f32_bf16 v40, v31, v131
    v_dot2c_f32_bf16 v40, v32, v132
    v_dot2c_f32_bf16 v40, v33, v133
    ds_read_b64 v[154:155], v2 offset:6560
    ds_read_b64 v[156:157], v2 offset:6568
    ds_read_b64 v[158:159], v2 offset:6576
    ds_read_b64 v[160:161], v2 offset:6584
    ds_read_b64 v[162:163], v2 offset:6592
    s_waitcnt lgkmcnt(10)
    v_dot2c_f32_bf16 v41, v24, v134
    v_dot2c_f32_bf16 v41, v25, v135
    v_dot2c_f32_bf16 v41, v26, v136
    v_dot2c_f32_bf16 v41, v27, v137
    v_dot2c_f32_bf16 v41, v28, v138
    v_dot2c_f32_bf16 v41, v29, v139
    v_dot2c_f32_bf16 v41, v30, v140
    v_dot2c_f32_bf16 v41, v31, v141
    v_dot2c_f32_bf16 v41, v32, v142
    v_dot2c_f32_bf16 v41, v33, v143
    ds_read_b64 v[164:165], v2 offset:5520
    ds_read_b64 v[166:167], v2 offset:5528
    ds_read_b64 v[168:169], v2 offset:5536
    ds_read_b64 v[170:171], v2 offset:5544
    ds_read_b64 v[172:173], v2 offset:5552
    v_mov_b32 v4, 0xf149f2ca
    s_mov_b32 s59, 0x3ea52b5c
    s_mov_b32 s60, 0x05040100
    s_mov_b32 s61, 0x07060302
    v_cmp_le_u32 vcc, 2, v3
    s_nop 1
    v_cndmask_b32 v35, v4, v35, vcc
    v_cmp_le_u32 vcc, 4, v3
    s_nop 1
    v_cndmask_b32 v36, v4, v36, vcc
    v_cmp_le_u32 vcc, 6, v3
    s_nop 1
    v_cndmask_b32 v37, v4, v37, vcc
    v_cmp_le_u32 vcc, 8, v3
    s_nop 1
    v_cndmask_b32 v38, v4, v38, vcc
    v_cmp_le_u32 vcc, 10, v3
    s_nop 1
    v_cndmask_b32 v39, v4, v39, vcc
    v_cmp_le_u32 vcc, 12, v3
    s_nop 1
    v_cndmask_b32 v40, v4, v40, vcc
    v_cmp_le_u32 vcc, 14, v3
    s_nop 1
    v_cndmask_b32 v41, v4, v41, vcc
    v_max3_f32 v5, v34, v35, v36
    v_max3_f32 v5, v5, v37, v38
    v_max3_f32 v5, v5, v39, v40
    v_max_f32 v5, v5, v41
    v_mul_f32 v5, s59, v5

    v_fma_f32 v34, v34, s59, -v5
    v_fma_f32 v35, v35, s59, -v5
    v_fma_f32 v36, v36, s59, -v5
    v_fma_f32 v37, v37, s59, -v5
    v_fma_f32 v38, v38, s59, -v5
    v_fma_f32 v39, v39, s59, -v5
    v_fma_f32 v40, v40, s59, -v5
    v_fma_f32 v41, v41, s59, -v5
    v_exp_f32 v34, v34
    v_exp_f32 v35, v35
    v_exp_f32 v36, v36
    v_exp_f32 v37, v37
    v_exp_f32 v38, v38
    v_exp_f32 v39, v39
    v_exp_f32 v40, v40
    v_exp_f32 v41, v41
    s_nop 0
    v_add_f32 v4, v34, v35
    v_add_f32 v5, v36, v37
    v_add_f32 v22, v38, v39
    v_add_f32 v23, v40, v41
    v_add_f32 v4, v4, v5
    v_add_f32 v22, v22, v23
    v_add_f32 v4, v4, v22
    v_rcp_f32 v4, v4
    s_nop 0

    v_mul_f32 v34, v4, v34
    v_mul_f32 v35, v4, v35
    v_mul_f32 v36, v4, v36
    v_mul_f32 v37, v4, v37
    v_mul_f32 v38, v4, v38
    v_mul_f32 v39, v4, v39
    v_mul_f32 v40, v4, v40
    v_mul_f32 v41, v4, v41
    v_cvt_pk_bf16_f32 v34, v34, v35
    v_cvt_pk_bf16_f32 v35, v36, v37
    v_cvt_pk_bf16_f32 v36, v38, v39
    v_cvt_pk_bf16_f32 v37, v40, v41
    ds_read_b64 v[174:175], v2 offset:4480
    ds_read_b64 v[176:177], v2 offset:4488
    ds_read_b64 v[178:179], v2 offset:4496
    ds_read_b64 v[180:181], v2 offset:4504
    ds_read_b64 v[182:183], v2 offset:4512
    s_waitcnt lgkmcnt(10)
    v_perm_b32 v22, v154, v144, s60
    v_perm_b32 v23, v154, v144, s61
    v_dot2c_f32_bf16 v44, v22, v34
    v_dot2c_f32_bf16 v45, v23, v34
    v_perm_b32 v22, v155, v145, s60
    v_perm_b32 v23, v155, v145, s61
    v_dot2c_f32_bf16 v46, v22, v34
    v_dot2c_f32_bf16 v47, v23, v34
    v_perm_b32 v22, v156, v146, s60
    v_perm_b32 v23, v156, v146, s61
    v_dot2c_f32_bf16 v48, v22, v34
    v_dot2c_f32_bf16 v49, v23, v34
    v_perm_b32 v22, v157, v147, s60
    v_perm_b32 v23, v157, v147, s61
    v_dot2c_f32_bf16 v50, v22, v34
    v_dot2c_f32_bf16 v51, v23, v34
    v_perm_b32 v22, v158, v148, s60
    v_perm_b32 v23, v158, v148, s61
    v_dot2c_f32_bf16 v52, v22, v34
    v_dot2c_f32_bf16 v53, v23, v34
    v_perm_b32 v22, v159, v149, s60
    v_perm_b32 v23, v159, v149, s61
    v_dot2c_f32_bf16 v54, v22, v34
    v_dot2c_f32_bf16 v55, v23, v34
    v_perm_b32 v22, v160, v150, s60
    v_perm_b32 v23, v160, v150, s61
    v_dot2c_f32_bf16 v56, v22, v34
    v_dot2c_f32_bf16 v57, v23, v34
    v_perm_b32 v22, v161, v151, s60
    v_perm_b32 v23, v161, v151, s61
    v_dot2c_f32_bf16 v58, v22, v34
    v_dot2c_f32_bf16 v59, v23, v34
    v_perm_b32 v22, v162, v152, s60
    v_perm_b32 v23, v162, v152, s61
    v_dot2c_f32_bf16 v60, v22, v34
    v_dot2c_f32_bf16 v61, v23, v34
    v_perm_b32 v22, v163, v153, s60
    v_perm_b32 v23, v163, v153, s61
    v_dot2c_f32_bf16 v62, v22, v34
    v_dot2c_f32_bf16 v63, v23, v34
    ds_read_b64 v[184:185], v2 offset:3440
    ds_read_b64 v[186:187], v2 offset:3448
    ds_read_b64 v[188:189], v2 offset:3456
    ds_read_b64 v[190:191], v2 offset:3464
    ds_read_b64 v[192:193], v2 offset:3472
    ds_read_b64 v[194:195], v2 offset:2400
    ds_read_b64 v[196:197], v2 offset:2408
    ds_read_b64 v[198:199], v2 offset:2416
    ds_read_b64 v[200:201], v2 offset:2424
    ds_read_b64 v[202:203], v2 offset:2432
    s_waitcnt lgkmcnt(10)
    v_perm_b32 v22, v174, v164, s60
    v_perm_b32 v23, v174, v164, s61
    v_dot2c_f32_bf16 v44, v22, v35
    v_dot2c_f32_bf16 v45, v23, v35
    v_perm_b32 v22, v175, v165, s60
    v_perm_b32 v23, v175, v165, s61
    v_dot2c_f32_bf16 v46, v22, v35
    v_dot2c_f32_bf16 v47, v23, v35
    v_perm_b32 v22, v176, v166, s60
    v_perm_b32 v23, v176, v166, s61
    v_dot2c_f32_bf16 v48, v22, v35
    v_dot2c_f32_bf16 v49, v23, v35
    v_perm_b32 v22, v177, v167, s60
    v_perm_b32 v23, v177, v167, s61
    v_dot2c_f32_bf16 v50, v22, v35
    v_dot2c_f32_bf16 v51, v23, v35
    v_perm_b32 v22, v178, v168, s60
    v_perm_b32 v23, v178, v168, s61
    v_dot2c_f32_bf16 v52, v22, v35
    v_dot2c_f32_bf16 v53, v23, v35
    v_perm_b32 v22, v179, v169, s60
    v_perm_b32 v23, v179, v169, s61
    v_dot2c_f32_bf16 v54, v22, v35
    v_dot2c_f32_bf16 v55, v23, v35
    v_perm_b32 v22, v180, v170, s60
    v_perm_b32 v23, v180, v170, s61
    v_dot2c_f32_bf16 v56, v22, v35
    v_dot2c_f32_bf16 v57, v23, v35
    v_perm_b32 v22, v181, v171, s60
    v_perm_b32 v23, v181, v171, s61
    v_dot2c_f32_bf16 v58, v22, v35
    v_dot2c_f32_bf16 v59, v23, v35
    v_perm_b32 v22, v182, v172, s60
    v_perm_b32 v23, v182, v172, s61
    v_dot2c_f32_bf16 v60, v22, v35
    v_dot2c_f32_bf16 v61, v23, v35
    v_perm_b32 v22, v183, v173, s60
    v_perm_b32 v23, v183, v173, s61
    v_dot2c_f32_bf16 v62, v22, v35
    v_dot2c_f32_bf16 v63, v23, v35
    ds_read_b64 v[204:205], v2 offset:1360
    ds_read_b64 v[206:207], v2 offset:1368
    ds_read_b64 v[208:209], v2 offset:1376
    ds_read_b64 v[210:211], v2 offset:1384
    ds_read_b64 v[212:213], v2 offset:1392
    ds_read_b64 v[214:215], v2 offset:320
    ds_read_b64 v[216:217], v2 offset:328
    ds_read_b64 v[218:219], v2 offset:336
    ds_read_b64 v[220:221], v2 offset:344
    ds_read_b64 v[222:223], v2 offset:352
    s_waitcnt lgkmcnt(10)
    v_perm_b32 v22, v194, v184, s60
    v_perm_b32 v23, v194, v184, s61
    v_dot2c_f32_bf16 v44, v22, v36
    v_dot2c_f32_bf16 v45, v23, v36
    v_perm_b32 v22, v195, v185, s60
    v_perm_b32 v23, v195, v185, s61
    v_dot2c_f32_bf16 v46, v22, v36
    v_dot2c_f32_bf16 v47, v23, v36
    v_perm_b32 v22, v196, v186, s60
    v_perm_b32 v23, v196, v186, s61
    v_dot2c_f32_bf16 v48, v22, v36
    v_dot2c_f32_bf16 v49, v23, v36
    v_perm_b32 v22, v197, v187, s60
    v_perm_b32 v23, v197, v187, s61
    v_dot2c_f32_bf16 v50, v22, v36
    v_dot2c_f32_bf16 v51, v23, v36
    v_perm_b32 v22, v198, v188, s60
    v_perm_b32 v23, v198, v188, s61
    v_dot2c_f32_bf16 v52, v22, v36
    v_dot2c_f32_bf16 v53, v23, v36
    v_perm_b32 v22, v199, v189, s60
    v_perm_b32 v23, v199, v189, s61
    v_dot2c_f32_bf16 v54, v22, v36
    v_dot2c_f32_bf16 v55, v23, v36
    v_perm_b32 v22, v200, v190, s60
    v_perm_b32 v23, v200, v190, s61
    v_dot2c_f32_bf16 v56, v22, v36
    v_dot2c_f32_bf16 v57, v23, v36
    v_perm_b32 v22, v201, v191, s60
    v_perm_b32 v23, v201, v191, s61
    v_dot2c_f32_bf16 v58, v22, v36
    v_dot2c_f32_bf16 v59, v23, v36
    v_perm_b32 v22, v202, v192, s60
    v_perm_b32 v23, v202, v192, s61
    v_dot2c_f32_bf16 v60, v22, v36
    v_dot2c_f32_bf16 v61, v23, v36
    v_perm_b32 v22, v203, v193, s60
    v_perm_b32 v23, v203, v193, s61
    v_dot2c_f32_bf16 v62, v22, v36
    v_dot2c_f32_bf16 v63, v23, v36
    s_waitcnt lgkmcnt(0)
    v_perm_b32 v22, v214, v204, s60
    v_perm_b32 v23, v214, v204, s61
    v_dot2c_f32_bf16 v44, v22, v37
    v_dot2c_f32_bf16 v45, v23, v37
    v_perm_b32 v22, v215, v205, s60
    v_perm_b32 v23, v215, v205, s61
    v_dot2c_f32_bf16 v46, v22, v37
    v_dot2c_f32_bf16 v47, v23, v37
    v_perm_b32 v22, v216, v206, s60
    v_perm_b32 v23, v216, v206, s61
    v_dot2c_f32_bf16 v48, v22, v37
    v_dot2c_f32_bf16 v49, v23, v37
    v_perm_b32 v22, v217, v207, s60
    v_perm_b32 v23, v217, v207, s61
    v_dot2c_f32_bf16 v50, v22, v37
    v_dot2c_f32_bf16 v51, v23, v37
    v_perm_b32 v22, v218, v208, s60
    v_perm_b32 v23, v218, v208, s61
    v_dot2c_f32_bf16 v52, v22, v37
    v_dot2c_f32_bf16 v53, v23, v37
    v_perm_b32 v22, v219, v209, s60
    v_perm_b32 v23, v219, v209, s61
    v_dot2c_f32_bf16 v54, v22, v37
    v_dot2c_f32_bf16 v55, v23, v37
    v_perm_b32 v22, v220, v210, s60
    v_perm_b32 v23, v220, v210, s61
    v_dot2c_f32_bf16 v56, v22, v37
    v_dot2c_f32_bf16 v57, v23, v37
    v_perm_b32 v22, v221, v211, s60
    v_perm_b32 v23, v221, v211, s61
    v_dot2c_f32_bf16 v58, v22, v37
    v_dot2c_f32_bf16 v59, v23, v37
    v_perm_b32 v22, v222, v212, s60
    v_perm_b32 v23, v222, v212, s61
    v_dot2c_f32_bf16 v60, v22, v37
    v_dot2c_f32_bf16 v61, v23, v37
    v_perm_b32 v22, v223, v213, s60
    v_perm_b32 v23, v223, v213, s61
    v_dot2c_f32_bf16 v62, v22, v37
    v_dot2c_f32_bf16 v63, v23, v37
    s_mov_b32 s36, s8
    s_mov_b32 s37, s9
    s_mov_b32 s38, 0x280000
    s_mov_b32 s39, 0x00020000
    v_mul_u32_u24 v2, 176, v1
    s_mul_i32 s49, s44, 40
    s_add_u32 s49, s49, 145408
    v_add_u32 v2, s49, v2

    v_cvt_pk_bf16_f32 v24, v44, v45
    v_cvt_pk_bf16_f32 v25, v46, v47
    ds_write_b64 v2, v[24:25] offset:0

    v_cvt_pk_bf16_f32 v26, v48, v49
    v_cvt_pk_bf16_f32 v27, v50, v51
    ds_write_b64 v2, v[26:27] offset:8

    v_cvt_pk_bf16_f32 v28, v52, v53
    v_cvt_pk_bf16_f32 v29, v54, v55
    ds_write_b64 v2, v[28:29] offset:16

    v_cvt_pk_bf16_f32 v30, v56, v57
    v_cvt_pk_bf16_f32 v31, v58, v59
    ds_write_b64 v2, v[30:31] offset:24

    v_cvt_pk_bf16_f32 v32, v60, v61
    v_cvt_pk_bf16_f32 v33, v62, v63
    ds_write_b64 v2, v[32:33] offset:32

    v_bfe_u32 v2, v0, 5, 2
    v_lshl_add_u32 v3, v2, 4, v7
    v_mul_u32_u24 v3, 176, v3
    v_lshrrev_b32 v4, 7, v0
    v_bfe_u32 v5, v0, 4, 1
    v_lshl_add_u32 v4, v4, 1, v5
    v_lshl_add_u32 v3, v4, 4, v3
    v_add_u32 v3, 145408, v3
    s_mul_i32 s49, s53, 10
    v_add_u32 v4, s49, v4
    v_lshrrev_b32 v5, 2, v4
    v_lshlrev_b32 v5, 17, v5
    v_and_b32 v4, 3, v4
    v_lshl_add_u32 v5, v4, 8, v5
    v_lshl_add_u32 v5, v2, 10, v5
    v_lshl_add_u32 v5, v7, 4, v5
    s_lshl_b32 s49, s52, 12
    s_add_u32 s58, s49, 0x20000
    s_add_u32 s59, s49, 0x40000
    s_cmp_lt_u32 s44, 2
    s_cselect_b32 s59, s59, 0x7ff00000
    s_waitcnt lgkmcnt(0)
    s_barrier
    ds_read_b128 v[24:27], v3
    ds_read_b128 v[28:31], v3 offset:64
    ds_read_b128 v[32:35], v3 offset:128
    s_waitcnt lgkmcnt(2)

    buffer_store_dwordx4 v[24:27], v5, s[36:39], s49 offen sc1
    s_waitcnt lgkmcnt(1)
    buffer_store_dwordx4 v[28:31], v5, s[36:39], s58 offen sc1
    s_waitcnt lgkmcnt(0)
    buffer_store_dwordx4 v[32:35], v5, s[36:39], s59 offen sc1
    s_waitcnt vmcnt(0)
    s_barrier
    s_add_u32 s36, s8, 0x980000
    s_addc_u32 s37, s9, 0
    s_mov_b32 s38, 0x10000
    s_mov_b32 s39, 0x00020000
    s_lshl_b32 s49, s2, 8
    v_mov_b32 v2, 0
    v_mov_b32 v3, 1
    v_cmp_eq_u32 vcc, 0, v0
    s_and_saveexec_b64 s[62:63], vcc
    s_cbranch_execz L_pub1
    buffer_store_dword v3, v2, s[36:39], s49 offen sc1

L_pub1:
    s_mov_b64 exec, s[62:63]
    s_mul_i32 s88, s51, 52
    s_lshr_b32 s88, s88, 8
    s_mul_i32 s49, s88, 5
    s_sub_u32 s97, s51, s49
    s_mul_i32 s89, s97, 3
    s_mul_i32 s49, s88, 5
    s_add_u32 s89, s89, s49
    s_lshl_b32 s49, s50, 1
    s_add_u32 s89, s89, s49
    s_and_b32 s89, s89, 15
    s_and_b32 s49, s50, 1
    s_mul_i32 s49, s49, 5
    s_add_u32 s97, s97, s49
    s_lshr_b32 s49, s50, 1
    s_mul_i32 s49, s49, 6
    s_add_u32 s88, s88, s49
    s_lshl_b32 s96, s44, 12
    s_mul_i32 s90, s44, 0x180000
    s_lshl_b32 s49, s88, 7
    s_add_u32 s90, s90, s49

    s_add_u32 s91, s90, 0x180000
    s_mul_i32 s3, s89, 0x18000
    s_add_u32 s90, s90, s3
    s_mov_b32 s92, s12
    s_mov_b32 s93, s13
    s_mov_b32 s94, 0x600000
    s_mov_b32 s95, 0x00020000
    v_lshrrev_b32 v2, 3, v1
    v_and_b32 v3, 6, v2
    v_and_b32 v4, 7, v1
    v_xor_b32 v3, v3, v4
    v_lshlrev_b32 v3, 4, v3

    s_mov_b32 s49, 3072
    v_and_b32 v4, 3, v2
    v_bfe_u32 v5, v2, 2, 1
    v_lshl_or_b32 v4, v5, 3, v4
    v_mad_u32_u24 v244, v4, s49, v3
    v_add_u32 v245, 0x2c00, v244
    v_add_u32 v246, 0xb800, v244
    v_add_u32 v247, 0xe400, v244
    s_add_u32 m0, s96, 0x0
    s_nop 0
    buffer_load_dwordx4 v244, s[92:95], s90 offen offset:0 lds
    buffer_load_dwordx4 v245, s[92:95], s90 offen offset:1024 lds
    buffer_load_dwordx4 v246, s[92:95], s90 offen offset:2048 lds
    buffer_load_dwordx4 v247, s[92:95], s90 offen offset:3072 lds
    s_add_u32 s90, s90, 0x18000
    s_cmp_ge_u32 s90, s91
    s_cselect_b32 s3, 0x180000, 0
    s_sub_u32 s90, s90, s3
    s_add_u32 m0, s96, 0x4000
    s_nop 0
    buffer_load_dwordx4 v244, s[92:95], s90 offen offset:0 lds
    buffer_load_dwordx4 v245, s[92:95], s90 offen offset:1024 lds
    buffer_load_dwordx4 v246, s[92:95], s90 offen offset:2048 lds
    buffer_load_dwordx4 v247, s[92:95], s90 offen offset:3072 lds
    s_add_u32 s90, s90, 0x18000
    s_cmp_ge_u32 s90, s91
    s_cselect_b32 s3, 0x180000, 0
    s_sub_u32 s90, s90, s3
    s_add_u32 m0, s96, 0x8000
    s_nop 0
    buffer_load_dwordx4 v244, s[92:95], s90 offen offset:0 lds
    buffer_load_dwordx4 v245, s[92:95], s90 offen offset:1024 lds
    buffer_load_dwordx4 v246, s[92:95], s90 offen offset:2048 lds
    buffer_load_dwordx4 v247, s[92:95], s90 offen offset:3072 lds
    s_add_u32 s90, s90, 0x18000
    s_cmp_ge_u32 s90, s91
    s_cselect_b32 s3, 0x180000, 0
    s_sub_u32 s90, s90, s3
    s_add_u32 m0, s96, 0xc000
    s_nop 0
    buffer_load_dwordx4 v244, s[92:95], s90 offen offset:0 lds
    buffer_load_dwordx4 v245, s[92:95], s90 offen offset:1024 lds
    buffer_load_dwordx4 v246, s[92:95], s90 offen offset:2048 lds
    buffer_load_dwordx4 v247, s[92:95], s90 offen offset:3072 lds
    s_add_u32 s90, s90, 0x18000
    s_cmp_ge_u32 s90, s91
    s_cselect_b32 s3, 0x180000, 0
    s_sub_u32 s90, s90, s3
    s_add_u32 m0, s96, 0x10000
    s_nop 0
    buffer_load_dwordx4 v244, s[92:95], s90 offen offset:0 lds
    buffer_load_dwordx4 v245, s[92:95], s90 offen offset:1024 lds
    buffer_load_dwordx4 v246, s[92:95], s90 offen offset:2048 lds
    buffer_load_dwordx4 v247, s[92:95], s90 offen offset:3072 lds
    s_add_u32 s90, s90, 0x18000
    s_cmp_ge_u32 s90, s91
    s_cselect_b32 s3, 0x180000, 0
    s_sub_u32 s90, s90, s3
    s_add_u32 m0, s96, 0x14000
    s_nop 0
    buffer_load_dwordx4 v244, s[92:95], s90 offen offset:0 lds
    buffer_load_dwordx4 v245, s[92:95], s90 offen offset:1024 lds
    buffer_load_dwordx4 v246, s[92:95], s90 offen offset:2048 lds
    buffer_load_dwordx4 v247, s[92:95], s90 offen offset:3072 lds
    s_add_u32 s90, s90, 0x18000
    s_cmp_ge_u32 s90, s91
    s_cselect_b32 s3, 0x180000, 0
    s_sub_u32 s90, s90, s3
    s_add_u32 m0, s96, 0x18000
    s_nop 0
    buffer_load_dwordx4 v244, s[92:95], s90 offen offset:0 lds
    buffer_load_dwordx4 v245, s[92:95], s90 offen offset:1024 lds
    buffer_load_dwordx4 v246, s[92:95], s90 offen offset:2048 lds
    buffer_load_dwordx4 v247, s[92:95], s90 offen offset:3072 lds
    s_add_u32 s90, s90, 0x18000
    s_cmp_ge_u32 s90, s91
    s_cselect_b32 s3, 0x180000, 0
    s_sub_u32 s90, s90, s3
    s_add_u32 m0, s96, 0x1c000
    s_nop 0
    buffer_load_dwordx4 v244, s[92:95], s90 offen offset:0 lds
    buffer_load_dwordx4 v245, s[92:95], s90 offen offset:1024 lds
    buffer_load_dwordx4 v246, s[92:95], s90 offen offset:2048 lds
    buffer_load_dwordx4 v247, s[92:95], s90 offen offset:3072 lds
    s_add_u32 s90, s90, 0x18000
    s_cmp_ge_u32 s90, s91
    s_cselect_b32 s3, 0x180000, 0
    s_sub_u32 s90, s90, s3
    s_add_u32 m0, s96, 0x20000
    s_nop 0
    buffer_load_dwordx4 v244, s[92:95], s90 offen offset:0 lds
    buffer_load_dwordx4 v245, s[92:95], s90 offen offset:1024 lds
    buffer_load_dwordx4 v246, s[92:95], s90 offen offset:2048 lds
    buffer_load_dwordx4 v247, s[92:95], s90 offen offset:3072 lds
    s_add_u32 s90, s90, 0x18000
    s_cmp_ge_u32 s90, s91
    s_cselect_b32 s3, 0x180000, 0
    s_sub_u32 s90, s90, s3
    v_bfe_u32 v2, v1, 2, 3
    v_bfe_u32 v3, v1, 5, 1
    v_lshl_or_b32 v2, v3, 4, v2
    v_and_b32 v3, 6, v2
    v_bfe_u32 v4, v1, 1, 1
    v_and_b32 v5, 1, v1
    v_lshlrev_b32 v5, 3, v5
    v_lshl_add_u32 v5, v2, 7, v5

    v_add_u32 v5, s96, v5
    v_or_b32 v6, 0, v4
    v_xor_b32 v6, v6, v3
    v_lshl_add_u32 v248, v6, 4, v5
    v_or_b32 v6, 2, v4
    v_xor_b32 v6, v6, v3
    v_lshl_add_u32 v249, v6, 4, v5
    v_or_b32 v6, 4, v4
    v_xor_b32 v6, v6, v3
    v_lshl_add_u32 v250, v6, 4, v5
    v_or_b32 v6, 6, v4
    v_xor_b32 v6, v6, v3
    v_lshl_add_u32 v251, v6, 4, v5
    v_and_b32 v7, 15, v1
    v_lshrrev_b32 v6, 4, v1
    s_and_b32 s57, s51, 7
    s_mul_i32 s57, s57, 160
    s_and_b32 s53, s51, 7
    s_lshr_b32 s52, s51, 3
    s_lshl_b32 s54, s50, 2
    s_add_u32 s52, s52, s54
    s_mul_i32 s45, s44, 0xa0000
    s_lshl_b32 s49, s52, 12
    s_add_u32 s45, s45, s49
    s_lshl_b32 s58, s52, 6
    s_lshl_b32 s49, s44, 4
    s_add_u32 s58, s58, s49
    s_mul_i32 s59, s58, 1280
    s_add_u32 s59, s59, s57
    v_mul_u32_u24 v2, 1280, v7
    v_lshl_add_u32 v22, v6, 4, v2
    v_cmp_gt_u32 vcc, 2, v6
    v_mov_b32 v3, 0x7ff00000
    s_nop 0
    v_cndmask_b32 v23, v3, v22, vcc

    s_add_u32 s64, s45, 0xa0000
    s_mul_i32 s3, s48, 0x20000
    s_add_u32 s45, s45, s3
    s_mov_b32 s40, s4
    s_mov_b32 s41, s5
    s_mov_b32 s42, 0x280000
    s_mov_b32 s43, 0x00020000
    buffer_load_dwordx4 v[232:235], v22, s[40:43], s59 offen
    buffer_load_dwordx4 v[236:239], v22, s[40:43], s59 offen offset:64
    buffer_load_dwordx4 v[240:243], v23, s[40:43], s59 offen offset:128
    s_mov_b32 s24, s8
    s_mov_b32 s25, s9
    s_mov_b32 s26, 0x280000
    s_mov_b32 s27, 0x00020000
    s_add_u32 s49, s44, 0
    s_and_b32 s49, s49, 3
    s_lshl_b32 s49, s49, 10
    v_lshl_add_u32 v8, v1, 4, s49
    s_add_u32 s49, s44, 1
    s_and_b32 s49, s49, 3
    s_lshl_b32 s49, s49, 10
    v_lshl_add_u32 v9, v1, 4, s49
    s_add_u32 s49, s44, 2
    s_and_b32 s49, s49, 3
    s_lshl_b32 s49, s49, 10
    v_lshl_add_u32 v10, v1, 4, s49
    s_add_u32 s49, s44, 3
    s_and_b32 s49, s49, 3
    s_lshl_b32 s49, s49, 10
    v_lshl_add_u32 v11, v1, 4, s49
    v_and_b32 v4, 1, v7
    v_lshlrev_b32 v4, 4, v4
    v_mov_b32 v5, 0x3f80
    v_lshlrev_b32 v5, v4, v5
    v_lshrrev_b32 v3, 3, v7
    v_sub_u32 v3, v6, v3
    v_bfe_u32 v4, v7, 1, 2
    v_lshl_add_u32 v3, v3, 1, v4
    v_and_b32 v2, 1, v6
    v_lshrrev_b32 v4, 3, v7
    v_cmp_eq_u32 vcc, v2, v4
    s_nop 1
    v_cndmask_b32 v5, 0, v5, vcc

    v_cmp_eq_u32 vcc, 0, v3
    s_nop 1
    v_cndmask_b32 v144, 0, v5, vcc
    v_cmp_eq_u32 vcc, 1, v3
    s_nop 1
    v_cndmask_b32 v145, 0, v5, vcc
    v_cmp_eq_u32 vcc, 2, v3
    s_nop 1
    v_cndmask_b32 v146, 0, v5, vcc
    v_cmp_eq_u32 vcc, 3, v3
    s_nop 1
    v_cndmask_b32 v147, 0, v5, vcc
    v_cmp_eq_u32 vcc, 4, v3
    s_nop 1
    v_cndmask_b32 v148, 0, v5, vcc
    v_cmp_eq_u32 vcc, 5, v3
    s_nop 1
    v_cndmask_b32 v149, 0, v5, vcc
    v_cmp_eq_u32 vcc, 6, v3
    s_nop 1
    v_cndmask_b32 v150, 0, v5, vcc
    v_cmp_eq_u32 vcc, 7, v3
    s_nop 1
    v_cndmask_b32 v151, 0, v5, vcc
    v_mov_b32 v64, 0
    v_mov_b32 v65, 0
    v_mov_b32 v66, 0
    v_mov_b32 v67, 0
    v_mov_b32 v68, 0
    v_mov_b32 v69, 0
    v_mov_b32 v70, 0
    v_mov_b32 v71, 0
    v_mov_b32 v72, 0
    v_mov_b32 v73, 0
    v_mov_b32 v74, 0
    v_mov_b32 v75, 0
    v_mov_b32 v76, 0
    v_mov_b32 v77, 0
    v_mov_b32 v78, 0
    v_mov_b32 v79, 0
    v_mov_b32 v80, 0
    v_mov_b32 v81, 0
    v_mov_b32 v82, 0
    v_mov_b32 v83, 0
    v_mov_b32 v84, 0
    v_mov_b32 v85, 0
    v_mov_b32 v86, 0
    v_mov_b32 v87, 0
    v_mov_b32 v88, 0
    v_mov_b32 v89, 0
    v_mov_b32 v90, 0
    v_mov_b32 v91, 0
    v_mov_b32 v92, 0
    v_mov_b32 v93, 0
    v_mov_b32 v94, 0
    v_mov_b32 v95, 0
    v_mov_b32 v96, 0
    v_mov_b32 v97, 0
    v_mov_b32 v98, 0
    v_mov_b32 v99, 0
    v_mov_b32 v100, 0
    v_mov_b32 v101, 0
    v_mov_b32 v102, 0
    v_mov_b32 v103, 0
    v_mov_b32 v104, 0
    v_mov_b32 v105, 0
    v_mov_b32 v106, 0
    v_mov_b32 v107, 0
    v_mov_b32 v108, 0
    v_mov_b32 v109, 0
    v_mov_b32 v110, 0
    v_mov_b32 v111, 0
    v_mov_b32 v112, 0
    v_mov_b32 v113, 0
    v_mov_b32 v114, 0
    v_mov_b32 v115, 0
    v_mov_b32 v116, 0
    v_mov_b32 v117, 0
    v_mov_b32 v118, 0
    v_mov_b32 v119, 0
    v_mov_b32 v120, 0
    v_mov_b32 v121, 0
    v_mov_b32 v122, 0
    v_mov_b32 v123, 0
    v_mov_b32 v124, 0
    v_mov_b32 v125, 0
    v_mov_b32 v126, 0
    v_mov_b32 v127, 0
    v_mov_b32 v128, 0
    v_mov_b32 v129, 0
    v_mov_b32 v130, 0
    v_mov_b32 v131, 0
    v_mov_b32 v132, 0
    v_mov_b32 v133, 0
    v_mov_b32 v134, 0
    v_mov_b32 v135, 0
    v_mov_b32 v136, 0
    v_mov_b32 v137, 0
    v_mov_b32 v138, 0
    v_mov_b32 v139, 0
    v_mov_b32 v140, 0
    v_mov_b32 v141, 0
    v_mov_b32 v142, 0
    v_mov_b32 v143, 0
    v_and_b32 v2, 1, v1
    s_lshl_b32 s49, s44, 1
    v_add_u32 v2, s49, v2
    v_and_b32 v3, 3, v2
    s_and_b32 s49, s52, 7
    s_lshl_b32 s49, s49, 2
    v_add_u32 v3, s49, v3
    v_lshrrev_b32 v2, 2, v2
    s_lshr_b32 s49, s52, 3
    s_lshl_b32 s49, s49, 1
    v_add_u32 v2, s49, v2
    v_lshl_add_u32 v2, v3, 3, v2
    v_lshlrev_b32 v2, 8, v2
    v_mov_b32 v3, 0
    s_mov_b32 s67, 0
    s_movk_i32 s66, 0x100

L_poll_s1:
    buffer_load_dword v5, v2, s[36:39], 0 offen sc1
    v_cmp_le_u32 s[62:63], s66, v254
    s_add_u32 s67, s67, 1
    s_waitcnt vmcnt(0)
    v_cmp_le_u32 vcc, 1, v5
    s_and_b64 vcc, vcc, s[62:63]
    s_cmp_eq_u64 vcc, -1
    s_cbranch_scc1 L_go_s1
    s_cmp_eq_u64 s[62:63], -1
    s_cbranch_scc1 L_poll_s1b
    buffer_load_dword v254, v3, s[32:35], 0 offen sc1
    s_waitcnt vmcnt(0)

L_poll_s1b:
    s_sleep 4
    s_cmp_lt_u32 s67, 262144
    s_cbranch_scc1 L_poll_s1

L_go_s1:
    buffer_load_dwordx4 v[152:155], v8, s[24:27], s45 offen sc1
    buffer_load_dwordx4 v[156:159], v9, s[24:27], s45 offen sc1
    buffer_load_dwordx4 v[160:163], v10, s[24:27], s45 offen sc1
    buffer_load_dwordx4 v[164:167], v11, s[24:27], s45 offen sc1
    s_add_u32 s45, s45, 0x20000
    s_cmp_ge_u32 s45, s64
    s_cselect_b32 s3, 0xa0000, 0
    s_sub_u32 s45, s45, s3
    buffer_load_dwordx4 v[168:171], v8, s[24:27], s45 offen sc1
    buffer_load_dwordx4 v[172:175], v9, s[24:27], s45 offen sc1
    buffer_load_dwordx4 v[176:179], v10, s[24:27], s45 offen sc1
    buffer_load_dwordx4 v[180:183], v11, s[24:27], s45 offen sc1
    s_add_u32 s45, s45, 0x20000
    s_cmp_ge_u32 s45, s64
    s_cselect_b32 s3, 0xa0000, 0
    s_sub_u32 s45, s45, s3
    buffer_load_dwordx4 v[184:187], v8, s[24:27], s45 offen sc1
    buffer_load_dwordx4 v[188:191], v9, s[24:27], s45 offen sc1
    buffer_load_dwordx4 v[192:195], v10, s[24:27], s45 offen sc1
    buffer_load_dwordx4 v[196:199], v11, s[24:27], s45 offen sc1
    s_add_u32 s45, s45, 0x20000
    s_cmp_ge_u32 s45, s64
    s_cselect_b32 s3, 0xa0000, 0
    s_sub_u32 s45, s45, s3
    buffer_load_dwordx4 v[200:203], v8, s[24:27], s45 offen sc1
    buffer_load_dwordx4 v[204:207], v9, s[24:27], s45 offen sc1
    buffer_load_dwordx4 v[208:211], v10, s[24:27], s45 offen sc1
    buffer_load_dwordx4 v[212:215], v11, s[24:27], s45 offen sc1
    s_add_u32 s45, s45, 0x20000
    s_cmp_ge_u32 s45, s64
    s_cselect_b32 s3, 0xa0000, 0
    s_sub_u32 s45, s45, s3
    buffer_load_dwordx4 v[216:219], v8, s[24:27], s45 offen sc1
    buffer_load_dwordx4 v[220:223], v9, s[24:27], s45 offen sc1
    buffer_load_dwordx4 v[224:227], v10, s[24:27], s45 offen sc1
    buffer_load_dwordx4 v[228:231], v11, s[24:27], s45 offen sc1
    s_add_u32 s45, s45, 0x20000
    s_cmp_ge_u32 s45, s64
    s_cselect_b32 s3, 0xa0000, 0
    s_sub_u32 s45, s45, s3
    s_mov_b32 s40, s16
    s_mov_b32 s41, s17
    s_mov_b32 s42, 0x600000
    s_mov_b32 s43, 0x00020000
    s_lshl_b32 s49, s51, 8
    v_add_u32 v2, s49, v0
    v_lshrrev_b32 v3, 3, v2
    v_and_b32 v2, 7, v2
    v_lshlrev_b32 v2, 7, v2
    v_lshl_add_u32 v2, v3, 12, v2
    s_lshr_b32 s49, s50, 1
    s_lshl_b32 s49, s49, 10
    s_add_u32 s59, s49, 0x400000

    buffer_load_dword v252, v2, s[40:43], s49 offen
    buffer_load_dword v253, v2, s[40:43], s59 offen
    ds_read_b64_tr_b16 a[0:1], v248 offset:0
    ds_read_b64_tr_b16 a[2:3], v248 offset:1024
    ds_read_b64_tr_b16 a[4:5], v249 offset:0
    ds_read_b64_tr_b16 a[6:7], v249 offset:1024
    ds_read_b64_tr_b16 a[8:9], v250 offset:0
    ds_read_b64_tr_b16 a[10:11], v250 offset:1024
    ds_read_b64_tr_b16 a[12:13], v251 offset:0
    ds_read_b64_tr_b16 a[14:15], v251 offset:1024
    ds_read_b64_tr_b16 a[16:17], v248 offset:16384
    ds_read_b64_tr_b16 a[18:19], v248 offset:17408
    ds_read_b64_tr_b16 a[20:21], v249 offset:16384
    ds_read_b64_tr_b16 a[22:23], v249 offset:17408
    ds_read_b64_tr_b16 a[24:25], v250 offset:16384
    ds_read_b64_tr_b16 a[26:27], v250 offset:17408
    ds_read_b64_tr_b16 a[28:29], v251 offset:16384
    ds_read_b64_tr_b16 a[30:31], v251 offset:17408
    ds_read_b64_tr_b16 a[32:33], v248 offset:32768
    ds_read_b64_tr_b16 a[34:35], v248 offset:33792
    ds_read_b64_tr_b16 a[36:37], v249 offset:32768
    ds_read_b64_tr_b16 a[38:39], v249 offset:33792
    ds_read_b64_tr_b16 a[40:41], v250 offset:32768
    ds_read_b64_tr_b16 a[42:43], v250 offset:33792
    ds_read_b64_tr_b16 a[44:45], v251 offset:32768
    ds_read_b64_tr_b16 a[46:47], v251 offset:33792
    ds_read_b64_tr_b16 a[48:49], v248 offset:49152
    ds_read_b64_tr_b16 a[50:51], v248 offset:50176
    ds_read_b64_tr_b16 a[52:53], v249 offset:49152
    ds_read_b64_tr_b16 a[54:55], v249 offset:50176
    ds_read_b64_tr_b16 a[56:57], v250 offset:49152
    ds_read_b64_tr_b16 a[58:59], v250 offset:50176
    ds_read_b64_tr_b16 a[60:61], v251 offset:49152
    ds_read_b64_tr_b16 a[62:63], v251 offset:50176
    v_add_u32 v248, 0x10000, v248
    v_add_u32 v249, 0x10000, v249
    v_add_u32 v250, 0x10000, v250
    v_add_u32 v251, 0x10000, v251
    ds_read_b64_tr_b16 a[64:65], v248 offset:0
    ds_read_b64_tr_b16 a[66:67], v248 offset:1024
    ds_read_b64_tr_b16 a[68:69], v249 offset:0
    ds_read_b64_tr_b16 a[70:71], v249 offset:1024
    ds_read_b64_tr_b16 a[72:73], v250 offset:0
    ds_read_b64_tr_b16 a[74:75], v250 offset:1024
    ds_read_b64_tr_b16 a[76:77], v251 offset:0
    ds_read_b64_tr_b16 a[78:79], v251 offset:1024
    ds_read_b64_tr_b16 a[80:81], v248 offset:16384
    ds_read_b64_tr_b16 a[82:83], v248 offset:17408
    ds_read_b64_tr_b16 a[84:85], v249 offset:16384
    ds_read_b64_tr_b16 a[86:87], v249 offset:17408
    ds_read_b64_tr_b16 a[88:89], v250 offset:16384
    ds_read_b64_tr_b16 a[90:91], v250 offset:17408
    ds_read_b64_tr_b16 a[92:93], v251 offset:16384
    ds_read_b64_tr_b16 a[94:95], v251 offset:17408
    ds_read_b64_tr_b16 a[96:97], v248 offset:32768
    ds_read_b64_tr_b16 a[98:99], v248 offset:33792
    ds_read_b64_tr_b16 a[100:101], v249 offset:32768
    ds_read_b64_tr_b16 a[102:103], v249 offset:33792
    ds_read_b64_tr_b16 a[104:105], v250 offset:32768
    ds_read_b64_tr_b16 a[106:107], v250 offset:33792
    ds_read_b64_tr_b16 a[108:109], v251 offset:32768
    ds_read_b64_tr_b16 a[110:111], v251 offset:33792
    ds_read_b64_tr_b16 a[112:113], v248 offset:49152
    ds_read_b64_tr_b16 a[114:115], v248 offset:50176
    ds_read_b64_tr_b16 a[116:117], v249 offset:49152
    ds_read_b64_tr_b16 a[118:119], v249 offset:50176
    ds_read_b64_tr_b16 a[120:121], v250 offset:49152
    ds_read_b64_tr_b16 a[122:123], v250 offset:50176
    ds_read_b64_tr_b16 a[124:125], v251 offset:49152
    ds_read_b64_tr_b16 a[126:127], v251 offset:50176
    v_add_u32 v248, 0x10000, v248
    v_add_u32 v249, 0x10000, v249
    v_add_u32 v250, 0x10000, v250
    v_add_u32 v251, 0x10000, v251
    ds_read_b64_tr_b16 a[128:129], v248 offset:0
    ds_read_b64_tr_b16 a[130:131], v248 offset:1024
    ds_read_b64_tr_b16 a[132:133], v249 offset:0
    ds_read_b64_tr_b16 a[134:135], v249 offset:1024
    ds_read_b64_tr_b16 a[136:137], v250 offset:0
    ds_read_b64_tr_b16 a[138:139], v250 offset:1024
    ds_read_b64_tr_b16 a[140:141], v251 offset:0
    ds_read_b64_tr_b16 a[142:143], v251 offset:1024
    v_subrev_u32 v248, 0x20000, v248
    v_subrev_u32 v249, 0x20000, v249
    v_subrev_u32 v250, 0x20000, v250
    v_subrev_u32 v251, 0x20000, v251
    s_waitcnt lgkmcnt(0)
    s_waitcnt vmcnt(18)
    v_mfma_f32_16x16x32_bf16 v[64:67], v[232:235], v[144:147], v[64:67]
    v_mfma_f32_16x16x32_bf16 v[68:71], v[232:235], v[148:151], v[68:71]
    v_mfma_f32_16x16x32_bf16 v[72:75], v[236:239], v[144:147], v[72:75]
    v_mfma_f32_16x16x32_bf16 v[76:79], v[236:239], v[148:151], v[76:79]
    v_mfma_f32_16x16x32_bf16 v[80:83], v[240:243], v[144:147], v[80:83]
    s_waitcnt lgkmcnt(0)
    v_mfma_f32_16x16x32_bf16 v[64:67], v[152:155], a[156:159], v[64:67]
    v_mfma_f32_16x16x32_bf16 v[84:87], v[156:159], a[156:159], v[84:87]
    v_mfma_f32_16x16x32_bf16 v[104:107], v[160:163], a[156:159], v[104:107]
    v_mfma_f32_16x16x32_bf16 v[124:127], v[164:167], a[156:159], v[124:127]
    v_mfma_f32_16x16x32_bf16 v[68:71], v[152:155], a[160:163], v[68:71]
    v_mfma_f32_16x16x32_bf16 v[88:91], v[156:159], a[160:163], v[88:91]
    v_mfma_f32_16x16x32_bf16 v[108:111], v[160:163], a[160:163], v[108:111]
    v_mfma_f32_16x16x32_bf16 v[128:131], v[164:167], a[160:163], v[128:131]
    v_mfma_f32_16x16x32_bf16 v[72:75], v[152:155], a[164:167], v[72:75]
    v_mfma_f32_16x16x32_bf16 v[92:95], v[156:159], a[164:167], v[92:95]
    v_mfma_f32_16x16x32_bf16 v[112:115], v[160:163], a[164:167], v[112:115]
    v_mfma_f32_16x16x32_bf16 v[132:135], v[164:167], a[164:167], v[132:135]
    v_mfma_f32_16x16x32_bf16 v[76:79], v[152:155], a[168:171], v[76:79]
    v_mfma_f32_16x16x32_bf16 v[96:99], v[156:159], a[168:171], v[96:99]
    v_mfma_f32_16x16x32_bf16 v[116:119], v[160:163], a[168:171], v[116:119]
    v_mfma_f32_16x16x32_bf16 v[136:139], v[164:167], a[168:171], v[136:139]
    v_mfma_f32_16x16x32_bf16 v[80:83], v[152:155], a[172:175], v[80:83]
    v_mfma_f32_16x16x32_bf16 v[100:103], v[156:159], a[172:175], v[100:103]
    s_waitcnt vmcnt(14)
    s_nop 0
    v_mfma_f32_16x16x32_bf16 v[120:123], v[160:163], a[172:175], v[120:123]
    v_mfma_f32_16x16x32_bf16 v[140:143], v[164:167], a[172:175], v[140:143]
    s_waitcnt lgkmcnt(0)
    v_mfma_f32_16x16x32_bf16 v[64:67], v[168:171], a[176:179], v[64:67]
    v_mfma_f32_16x16x32_bf16 v[84:87], v[172:175], a[176:179], v[84:87]
    v_mfma_f32_16x16x32_bf16 v[104:107], v[176:179], a[176:179], v[104:107]
    v_mfma_f32_16x16x32_bf16 v[124:127], v[180:183], a[176:179], v[124:127]
    v_mfma_f32_16x16x32_bf16 v[68:71], v[168:171], a[180:183], v[68:71]
    v_mfma_f32_16x16x32_bf16 v[88:91], v[172:175], a[180:183], v[88:91]
    v_mfma_f32_16x16x32_bf16 v[108:111], v[176:179], a[180:183], v[108:111]
    v_mfma_f32_16x16x32_bf16 v[128:131], v[180:183], a[180:183], v[128:131]
    v_mfma_f32_16x16x32_bf16 v[72:75], v[168:171], a[184:187], v[72:75]
    v_mfma_f32_16x16x32_bf16 v[92:95], v[172:175], a[184:187], v[92:95]
    v_mfma_f32_16x16x32_bf16 v[112:115], v[176:179], a[184:187], v[112:115]
    v_mfma_f32_16x16x32_bf16 v[132:135], v[180:183], a[184:187], v[132:135]
    v_mfma_f32_16x16x32_bf16 v[76:79], v[168:171], a[188:191], v[76:79]
    v_mfma_f32_16x16x32_bf16 v[96:99], v[172:175], a[188:191], v[96:99]
    v_mfma_f32_16x16x32_bf16 v[116:119], v[176:179], a[188:191], v[116:119]
    v_mfma_f32_16x16x32_bf16 v[136:139], v[180:183], a[188:191], v[136:139]
    v_mfma_f32_16x16x32_bf16 v[80:83], v[168:171], a[192:195], v[80:83]
    v_mfma_f32_16x16x32_bf16 v[100:103], v[172:175], a[192:195], v[100:103]
    s_waitcnt vmcnt(10)
    s_nop 0
    v_mfma_f32_16x16x32_bf16 v[120:123], v[176:179], a[192:195], v[120:123]
    v_mfma_f32_16x16x32_bf16 v[140:143], v[180:183], a[192:195], v[140:143]
    s_waitcnt lgkmcnt(0)
    v_mfma_f32_16x16x32_bf16 v[64:67], v[184:187], a[196:199], v[64:67]
    v_mfma_f32_16x16x32_bf16 v[84:87], v[188:191], a[196:199], v[84:87]
    v_mfma_f32_16x16x32_bf16 v[104:107], v[192:195], a[196:199], v[104:107]
    v_mfma_f32_16x16x32_bf16 v[124:127], v[196:199], a[196:199], v[124:127]
    v_mfma_f32_16x16x32_bf16 v[68:71], v[184:187], a[200:203], v[68:71]
    v_mfma_f32_16x16x32_bf16 v[88:91], v[188:191], a[200:203], v[88:91]
    v_mfma_f32_16x16x32_bf16 v[108:111], v[192:195], a[200:203], v[108:111]
    v_mfma_f32_16x16x32_bf16 v[128:131], v[196:199], a[200:203], v[128:131]
    v_mfma_f32_16x16x32_bf16 v[72:75], v[184:187], a[204:207], v[72:75]
    v_mfma_f32_16x16x32_bf16 v[92:95], v[188:191], a[204:207], v[92:95]
    v_mfma_f32_16x16x32_bf16 v[112:115], v[192:195], a[204:207], v[112:115]
    v_mfma_f32_16x16x32_bf16 v[132:135], v[196:199], a[204:207], v[132:135]
    v_mfma_f32_16x16x32_bf16 v[76:79], v[184:187], a[208:211], v[76:79]
    v_mfma_f32_16x16x32_bf16 v[96:99], v[188:191], a[208:211], v[96:99]
    v_mfma_f32_16x16x32_bf16 v[116:119], v[192:195], a[208:211], v[116:119]
    v_mfma_f32_16x16x32_bf16 v[136:139], v[196:199], a[208:211], v[136:139]
    v_mfma_f32_16x16x32_bf16 v[80:83], v[184:187], a[212:215], v[80:83]
    v_mfma_f32_16x16x32_bf16 v[100:103], v[188:191], a[212:215], v[100:103]
    s_waitcnt vmcnt(6)
    s_nop 0
    v_mfma_f32_16x16x32_bf16 v[120:123], v[192:195], a[212:215], v[120:123]
    v_mfma_f32_16x16x32_bf16 v[140:143], v[196:199], a[212:215], v[140:143]
    s_waitcnt lgkmcnt(0)
    v_mfma_f32_16x16x32_bf16 v[64:67], v[200:203], a[216:219], v[64:67]
    v_mfma_f32_16x16x32_bf16 v[84:87], v[204:207], a[216:219], v[84:87]
    v_mfma_f32_16x16x32_bf16 v[104:107], v[208:211], a[216:219], v[104:107]
    v_mfma_f32_16x16x32_bf16 v[124:127], v[212:215], a[216:219], v[124:127]
    v_mfma_f32_16x16x32_bf16 v[68:71], v[200:203], a[220:223], v[68:71]
    v_mfma_f32_16x16x32_bf16 v[88:91], v[204:207], a[220:223], v[88:91]
    v_mfma_f32_16x16x32_bf16 v[108:111], v[208:211], a[220:223], v[108:111]
    v_mfma_f32_16x16x32_bf16 v[128:131], v[212:215], a[220:223], v[128:131]
    v_mfma_f32_16x16x32_bf16 v[72:75], v[200:203], a[224:227], v[72:75]
    v_mfma_f32_16x16x32_bf16 v[92:95], v[204:207], a[224:227], v[92:95]
    v_mfma_f32_16x16x32_bf16 v[112:115], v[208:211], a[224:227], v[112:115]
    v_mfma_f32_16x16x32_bf16 v[132:135], v[212:215], a[224:227], v[132:135]
    v_mfma_f32_16x16x32_bf16 v[76:79], v[200:203], a[228:231], v[76:79]
    v_mfma_f32_16x16x32_bf16 v[96:99], v[204:207], a[228:231], v[96:99]
    v_mfma_f32_16x16x32_bf16 v[116:119], v[208:211], a[228:231], v[116:119]
    v_mfma_f32_16x16x32_bf16 v[136:139], v[212:215], a[228:231], v[136:139]
    v_mfma_f32_16x16x32_bf16 v[80:83], v[200:203], a[232:235], v[80:83]
    v_mfma_f32_16x16x32_bf16 v[100:103], v[204:207], a[232:235], v[100:103]
    s_waitcnt vmcnt(2)
    s_nop 0
    v_mfma_f32_16x16x32_bf16 v[120:123], v[208:211], a[232:235], v[120:123]
    v_mfma_f32_16x16x32_bf16 v[140:143], v[212:215], a[232:235], v[140:143]
    s_waitcnt lgkmcnt(0)
    v_mfma_f32_16x16x32_bf16 v[64:67], v[216:219], a[236:239], v[64:67]
    v_mfma_f32_16x16x32_bf16 v[84:87], v[220:223], a[236:239], v[84:87]
    v_mfma_f32_16x16x32_bf16 v[104:107], v[224:227], a[236:239], v[104:107]
    v_mfma_f32_16x16x32_bf16 v[124:127], v[228:231], a[236:239], v[124:127]
    v_mfma_f32_16x16x32_bf16 v[68:71], v[216:219], a[240:243], v[68:71]
    v_mfma_f32_16x16x32_bf16 v[88:91], v[220:223], a[240:243], v[88:91]
    v_mfma_f32_16x16x32_bf16 v[108:111], v[224:227], a[240:243], v[108:111]
    v_mfma_f32_16x16x32_bf16 v[128:131], v[228:231], a[240:243], v[128:131]
    v_mfma_f32_16x16x32_bf16 v[72:75], v[216:219], a[244:247], v[72:75]
    v_mfma_f32_16x16x32_bf16 v[92:95], v[220:223], a[244:247], v[92:95]
    v_mfma_f32_16x16x32_bf16 v[112:115], v[224:227], a[244:247], v[112:115]
    v_mfma_f32_16x16x32_bf16 v[132:135], v[228:231], a[244:247], v[132:135]
    v_mfma_f32_16x16x32_bf16 v[76:79], v[216:219], a[248:251], v[76:79]
    v_mfma_f32_16x16x32_bf16 v[96:99], v[220:223], a[248:251], v[96:99]
    v_mfma_f32_16x16x32_bf16 v[116:119], v[224:227], a[248:251], v[116:119]
    v_mfma_f32_16x16x32_bf16 v[136:139], v[228:231], a[248:251], v[136:139]
    v_mfma_f32_16x16x32_bf16 v[80:83], v[216:219], a[252:255], v[80:83]
    v_mfma_f32_16x16x32_bf16 v[100:103], v[220:223], a[252:255], v[100:103]
    v_mfma_f32_16x16x32_bf16 v[120:123], v[224:227], a[252:255], v[120:123]
    v_mfma_f32_16x16x32_bf16 v[140:143], v[228:231], a[252:255], v[140:143]
    s_sub_u32 s49, s44, 0
    s_and_b32 s49, s49, 3
    s_mul_i32 s49, s49, 0x3c00
    s_add_u32 s49, s49, 0xa800
    v_lshl_add_u32 v2, v1, 4, s49
    s_sub_u32 s49, s44, 1
    s_and_b32 s49, s49, 3
    s_mul_i32 s49, s49, 0x3c00
    s_add_u32 s49, s49, 0xa800
    v_lshl_add_u32 v3, v1, 4, s49
    s_sub_u32 s49, s44, 2
    s_and_b32 s49, s49, 3
    s_mul_i32 s49, s49, 0x3c00
    s_add_u32 s49, s49, 0xa800
    v_lshl_add_u32 v4, v1, 4, s49
    s_sub_u32 s49, s44, 3
    s_and_b32 s49, s49, 3
    s_mul_i32 s49, s49, 0x3c00
    s_add_u32 s49, s49, 0xa800
    v_lshl_add_u32 v5, v1, 4, s49
    s_barrier
    ds_write_b128 v2, v[84:87] offset:0
    ds_write_b128 v2, v[88:91] offset:1024
    ds_write_b128 v2, v[92:95] offset:2048
    ds_write_b128 v2, v[96:99] offset:3072
    ds_write_b128 v2, v[100:103] offset:4096
    ds_write_b128 v2, v[104:107] offset:5120
    ds_write_b128 v2, v[108:111] offset:6144
    ds_write_b128 v2, v[112:115] offset:7168
    ds_write_b128 v2, v[116:119] offset:8192
    ds_write_b128 v2, v[120:123] offset:9216
    ds_write_b128 v2, v[124:127] offset:10240
    ds_write_b128 v2, v[128:131] offset:11264
    ds_write_b128 v2, v[132:135] offset:12288
    ds_write_b128 v2, v[136:139] offset:13312
    ds_write_b128 v2, v[140:143] offset:14336
    s_waitcnt lgkmcnt(0)
    s_barrier
    ds_read_b128 v[84:87], v3 offset:0
    ds_read_b128 v[88:91], v3 offset:1024
    ds_read_b128 v[92:95], v3 offset:2048
    ds_read_b128 v[96:99], v3 offset:3072
    ds_read_b128 v[100:103], v3 offset:4096
    ds_read_b128 v[104:107], v4 offset:5120
    ds_read_b128 v[108:111], v4 offset:6144
    ds_read_b128 v[112:115], v4 offset:7168
    ds_read_b128 v[116:119], v4 offset:8192
    ds_read_b128 v[120:123], v4 offset:9216
    ds_read_b128 v[124:127], v5 offset:10240
    ds_read_b128 v[128:131], v5 offset:11264
    ds_read_b128 v[132:135], v5 offset:12288
    ds_read_b128 v[136:139], v5 offset:13312
    ds_read_b128 v[140:143], v5 offset:14336
    s_waitcnt lgkmcnt(14)
    v_pk_add_f32 v[64:65], v[64:65], v[84:85]
    v_pk_add_f32 v[66:67], v[66:67], v[86:87]
    s_waitcnt lgkmcnt(13)
    v_pk_add_f32 v[68:69], v[68:69], v[88:89]
    v_pk_add_f32 v[70:71], v[70:71], v[90:91]
    s_waitcnt lgkmcnt(12)
    v_pk_add_f32 v[72:73], v[72:73], v[92:93]
    v_pk_add_f32 v[74:75], v[74:75], v[94:95]
    s_waitcnt lgkmcnt(11)
    v_pk_add_f32 v[76:77], v[76:77], v[96:97]
    v_pk_add_f32 v[78:79], v[78:79], v[98:99]
    s_waitcnt lgkmcnt(10)
    v_pk_add_f32 v[80:81], v[80:81], v[100:101]
    v_pk_add_f32 v[82:83], v[82:83], v[102:103]
    s_waitcnt lgkmcnt(9)
    v_pk_add_f32 v[64:65], v[64:65], v[104:105]
    v_pk_add_f32 v[66:67], v[66:67], v[106:107]
    s_waitcnt lgkmcnt(8)
    v_pk_add_f32 v[68:69], v[68:69], v[108:109]
    v_pk_add_f32 v[70:71], v[70:71], v[110:111]
    s_waitcnt lgkmcnt(7)
    v_pk_add_f32 v[72:73], v[72:73], v[112:113]
    v_pk_add_f32 v[74:75], v[74:75], v[114:115]
    s_waitcnt lgkmcnt(6)
    v_pk_add_f32 v[76:77], v[76:77], v[116:117]
    v_pk_add_f32 v[78:79], v[78:79], v[118:119]
    s_waitcnt lgkmcnt(5)
    v_pk_add_f32 v[80:81], v[80:81], v[120:121]
    v_pk_add_f32 v[82:83], v[82:83], v[122:123]
    s_waitcnt lgkmcnt(4)
    v_pk_add_f32 v[64:65], v[64:65], v[124:125]
    v_pk_add_f32 v[66:67], v[66:67], v[126:127]
    s_waitcnt lgkmcnt(3)
    v_pk_add_f32 v[68:69], v[68:69], v[128:129]
    v_pk_add_f32 v[70:71], v[70:71], v[130:131]
    s_waitcnt lgkmcnt(2)
    v_pk_add_f32 v[72:73], v[72:73], v[132:133]
    v_pk_add_f32 v[74:75], v[74:75], v[134:135]
    s_waitcnt lgkmcnt(1)
    v_pk_add_f32 v[76:77], v[76:77], v[136:137]
    v_pk_add_f32 v[78:79], v[78:79], v[138:139]
    s_waitcnt lgkmcnt(0)
    v_pk_add_f32 v[80:81], v[80:81], v[140:141]
    v_pk_add_f32 v[82:83], v[82:83], v[142:143]
    s_add_u32 s32, s8, 0x960000
    s_addc_u32 s33, s9, 0
    s_mov_b32 s34, 0x20000
    s_mov_b32 s35, 0x00020000
    s_add_u32 s40, s8, 0x280000
    s_addc_u32 s41, s9, 0
    s_mov_b32 s42, 0x500000
    s_mov_b32 s43, 0x00020000
    v_pk_add_f32 v[24:25], v[64:65], v[68:69]
    v_pk_add_f32 v[26:27], v[66:67], v[70:71]
    v_pk_mul_f32 v[28:29], v[64:65], v[64:65]
    v_pk_mul_f32 v[30:31], v[66:67], v[66:67]
    v_pk_fma_f32 v[28:29], v[68:69], v[68:69], v[28:29]
    v_pk_fma_f32 v[30:31], v[70:71], v[70:71], v[30:31]

    v_pk_add_f32 v[24:25], v[24:25], v[72:73]
    v_pk_add_f32 v[26:27], v[26:27], v[74:75]
    v_pk_fma_f32 v[28:29], v[72:73], v[72:73], v[28:29]
    v_pk_fma_f32 v[30:31], v[74:75], v[74:75], v[30:31]

    v_pk_add_f32 v[24:25], v[24:25], v[76:77]
    v_pk_add_f32 v[26:27], v[26:27], v[78:79]
    v_pk_fma_f32 v[28:29], v[76:77], v[76:77], v[28:29]
    v_pk_fma_f32 v[30:31], v[78:79], v[78:79], v[30:31]

    v_pk_add_f32 v[24:25], v[24:25], v[80:81]
    v_pk_add_f32 v[26:27], v[26:27], v[82:83]
    v_pk_fma_f32 v[28:29], v[80:81], v[80:81], v[28:29]
    v_pk_fma_f32 v[30:31], v[82:83], v[82:83], v[30:31]

    s_nop 1
    v_add_f32_dpp v24, v24, v24 row_ror:8 row_mask:0xf bank_mask:0xf
    v_add_f32_dpp v25, v25, v25 row_ror:8 row_mask:0xf bank_mask:0xf
    v_add_f32_dpp v26, v26, v26 row_ror:8 row_mask:0xf bank_mask:0xf
    v_add_f32_dpp v27, v27, v27 row_ror:8 row_mask:0xf bank_mask:0xf
    v_add_f32_dpp v28, v28, v28 row_ror:8 row_mask:0xf bank_mask:0xf
    v_add_f32_dpp v29, v29, v29 row_ror:8 row_mask:0xf bank_mask:0xf
    v_add_f32_dpp v30, v30, v30 row_ror:8 row_mask:0xf bank_mask:0xf
    v_add_f32_dpp v31, v31, v31 row_ror:8 row_mask:0xf bank_mask:0xf
    v_add_f32_dpp v24, v24, v24 row_ror:4 row_mask:0xf bank_mask:0xf
    v_add_f32_dpp v25, v25, v25 row_ror:4 row_mask:0xf bank_mask:0xf
    v_add_f32_dpp v26, v26, v26 row_ror:4 row_mask:0xf bank_mask:0xf
    v_add_f32_dpp v27, v27, v27 row_ror:4 row_mask:0xf bank_mask:0xf
    v_add_f32_dpp v28, v28, v28 row_ror:4 row_mask:0xf bank_mask:0xf
    v_add_f32_dpp v29, v29, v29 row_ror:4 row_mask:0xf bank_mask:0xf
    v_add_f32_dpp v30, v30, v30 row_ror:4 row_mask:0xf bank_mask:0xf
    v_add_f32_dpp v31, v31, v31 row_ror:4 row_mask:0xf bank_mask:0xf
    v_add_f32_dpp v24, v24, v24 row_ror:2 row_mask:0xf bank_mask:0xf
    v_add_f32_dpp v25, v25, v25 row_ror:2 row_mask:0xf bank_mask:0xf
    v_add_f32_dpp v26, v26, v26 row_ror:2 row_mask:0xf bank_mask:0xf
    v_add_f32_dpp v27, v27, v27 row_ror:2 row_mask:0xf bank_mask:0xf
    v_add_f32_dpp v28, v28, v28 row_ror:2 row_mask:0xf bank_mask:0xf
    v_add_f32_dpp v29, v29, v29 row_ror:2 row_mask:0xf bank_mask:0xf
    v_add_f32_dpp v30, v30, v30 row_ror:2 row_mask:0xf bank_mask:0xf
    v_add_f32_dpp v31, v31, v31 row_ror:2 row_mask:0xf bank_mask:0xf
    v_add_f32_dpp v24, v24, v24 row_ror:1 row_mask:0xf bank_mask:0xf
    v_add_f32_dpp v25, v25, v25 row_ror:1 row_mask:0xf bank_mask:0xf
    v_add_f32_dpp v26, v26, v26 row_ror:1 row_mask:0xf bank_mask:0xf
    v_add_f32_dpp v27, v27, v27 row_ror:1 row_mask:0xf bank_mask:0xf
    v_add_f32_dpp v28, v28, v28 row_ror:1 row_mask:0xf bank_mask:0xf
    v_add_f32_dpp v29, v29, v29 row_ror:1 row_mask:0xf bank_mask:0xf
    v_add_f32_dpp v30, v30, v30 row_ror:1 row_mask:0xf bank_mask:0xf
    v_add_f32_dpp v31, v31, v31 row_ror:1 row_mask:0xf bank_mask:0xf
    v_cmp_eq_u32 vcc, 1, v7
    v_cmp_eq_u32 s[62:63], 2, v7
    v_cmp_eq_u32 s[64:65], 3, v7
    s_nop 0
    v_cndmask_b32 v2, v24, v25, vcc
    v_cndmask_b32 v3, v28, v29, vcc
    v_cndmask_b32 v2, v2, v26, s[62:63]
    v_cndmask_b32 v3, v3, v30, s[62:63]
    v_cndmask_b32 v2, v2, v27, s[64:65]
    v_cndmask_b32 v3, v3, v31, s[64:65]
    v_mov_b32 v4, 0x7fc00000
    v_cmp_eq_u32 vcc, -1, v3
    v_lshl_add_u32 v5, v6, 2, v7
    v_lshlrev_b32 v5, 3, v5
    v_cndmask_b32 v3, v3, v4, vcc
    s_lshl_b32 s60, s58, 6
    s_lshl_b32 s49, s53, 7
    s_add_u32 s61, s60, s49
    v_cmp_gt_u32 vcc, 4, v7
    s_and_saveexec_b64 s[62:63], vcc
    buffer_store_dwordx2 v[2:3], v5, s[32:35], s61 offen sc1
    s_mov_b64 exec, s[62:63]

    s_lshl_b32 s61, s52, 1
    s_lshr_b32 s49, s44, 1
    s_add_u32 s61, s61, s49
    s_mul_i32 s61, s61, 40
    s_mul_i32 s49, s53, 5
    s_add_u32 s61, s61, s49
    s_lshl_b32 s61, s61, 10
    s_and_b32 s49, s44, 1
    s_lshl_b32 s49, s49, 9
    s_add_u32 s61, s61, s49
    s_add_u32 s66, s61, 0x280000
    v_and_b32 v2, 1, v6
    v_lshrrev_b32 v3, 1, v6
    v_lshlrev_b32 v3, 8, v3
    v_lshl_add_u32 v3, v7, 4, v3
    v_lshl_add_u32 v22, v2, 10, v3
    v_add_u32 v3, 0x1000, v3
    v_cmp_eq_u32 vcc, 0, v2
    v_mov_b32 v4, 0x7ff00000
    v_lshlrev_b32 v21, 4, v1
    v_cndmask_b32 v23, v4, v3, vcc

    v_cvt_pk_bf16_f32 v36, v64, v65
    v_cvt_pk_bf16_f32 v37, v66, v67
    v_cvt_pk_bf16_f32 v38, v68, v69
    v_cvt_pk_bf16_f32 v39, v70, v71
    v_cvt_pk_bf16_f32 v40, v72, v73
    v_cvt_pk_bf16_f32 v41, v74, v75
    v_cvt_pk_bf16_f32 v42, v76, v77
    v_cvt_pk_bf16_f32 v43, v78, v79
    v_cvt_pk_bf16_f32 v44, v80, v81
    v_cvt_pk_bf16_f32 v45, v82, v83
    s_nop 1
    v_permlane16_swap_b32 v36, v38
    v_permlane16_swap_b32 v37, v39
    v_permlane16_swap_b32 v40, v42
    v_permlane16_swap_b32 v41, v43
    v_permlane16_swap_b32 v44, v46
    v_permlane16_swap_b32 v45, v47
    buffer_store_dwordx4 v[36:39], v22, s[40:43], s61 offen offset:0 sc1
    buffer_store_dwordx4 v[40:43], v22, s[40:43], s61 offen offset:2048 sc1
    buffer_store_dwordx4 v[44:47], v23, s[40:43], s61 offen sc1
    s_mov_b32 s67, 0
L_b_poll:
    buffer_load_dwordx4 v[24:27], v21, s[32:35], s60 offen sc1
    s_add_u32 s67, s67, 1
    s_waitcnt vmcnt(0)
    v_cmp_ne_u32 vcc, -1, v25
    v_cmp_ne_u32 s[62:63], -1, v27
    s_and_b64 vcc, vcc, s[62:63]
    s_cmp_eq_u64 vcc, -1
    s_cbranch_scc1 L_b_go
    s_sleep 2
    s_cmp_lt_u32 s67, 262144
    s_cbranch_scc1 L_b_poll

L_b_go:
    s_nop 0

    v_add_f32_dpp v24, v24, v24 row_ror:8 row_mask:0xf bank_mask:0xf
    v_add_f32_dpp v25, v25, v25 row_ror:8 row_mask:0xf bank_mask:0xf
    v_add_f32_dpp v26, v26, v26 row_ror:8 row_mask:0xf bank_mask:0xf
    v_add_f32_dpp v27, v27, v27 row_ror:8 row_mask:0xf bank_mask:0xf
    v_mov_b32 v28, v24
    v_mov_b32 v29, v25
    v_mov_b32 v30, v26
    v_mov_b32 v31, v27
    s_nop 1
    v_permlane16_swap_b32 v28, v24
    v_permlane16_swap_b32 v29, v25
    v_permlane16_swap_b32 v30, v26
    v_permlane16_swap_b32 v31, v27
    v_add_f32 v24, v24, v28
    v_add_f32 v25, v25, v29
    v_add_f32 v26, v26, v30
    v_add_f32 v27, v27, v31
    v_mov_b32 v28, v24
    v_mov_b32 v29, v25
    v_mov_b32 v30, v26
    v_mov_b32 v31, v27
    s_nop 1
    v_permlane32_swap_b32 v28, v24
    v_permlane32_swap_b32 v29, v25
    v_permlane32_swap_b32 v30, v26
    v_permlane32_swap_b32 v31, v27
    v_add_f32 v24, v24, v28
    v_add_f32 v25, v25, v29
    v_add_f32 v26, v26, v30
    v_add_f32 v27, v27, v31
    v_mul_f32 v24, 0x3acccccd, v24
    v_mul_f32 v25, 0x3acccccd, v25
    v_fma_f32 v25, -v24, v24, v25
    v_max_f32 v25, 0, v25
    v_add_f32 v2, 0x3727c5ac, v25
    v_rsq_f32 v3, v2
    v_rcp_f32 v2, v2
    s_nop 0
    v_mul_f32 v2, v25, v2
    v_add_f32 v2, 0x3727c5ac, v2
    v_rsq_f32 v2, v2
    s_nop 0
    v_mul_f32 v25, v3, v2
    v_mul_f32 v24, v24, v25

    v_mul_f32 v26, 0x3acccccd, v26
    v_mul_f32 v27, 0x3acccccd, v27
    v_fma_f32 v27, -v26, v26, v27
    v_max_f32 v27, 0, v27
    v_add_f32 v4, 0x3727c5ac, v27
    v_rsq_f32 v5, v4
    v_rcp_f32 v4, v4
    s_nop 0
    v_mul_f32 v4, v27, v4
    v_add_f32 v4, 0x3727c5ac, v4
    v_rsq_f32 v4, v4
    s_nop 0
    v_mul_f32 v27, v5, v4
    v_mul_f32 v26, v26, v27

    s_nop 1
    v_mov_b32_dpp v28, v25 row_newbcast:0 row_mask:0x1 bank_mask:0xf
    v_mov_b32_dpp v32, v24 row_newbcast:0 row_mask:0x1 bank_mask:0xf
    v_mov_b32_dpp v28, v25 row_newbcast:2 row_mask:0x2 bank_mask:0xf
    v_mov_b32_dpp v32, v24 row_newbcast:2 row_mask:0x2 bank_mask:0xf
    v_mov_b32_dpp v28, v25 row_newbcast:4 row_mask:0x4 bank_mask:0xf
    v_mov_b32_dpp v32, v24 row_newbcast:4 row_mask:0x4 bank_mask:0xf
    v_mov_b32_dpp v28, v25 row_newbcast:6 row_mask:0x8 bank_mask:0xf
    v_mov_b32_dpp v32, v24 row_newbcast:6 row_mask:0x8 bank_mask:0xf
    v_mov_b32_dpp v29, v27 row_newbcast:0 row_mask:0x1 bank_mask:0xf
    v_mov_b32_dpp v33, v26 row_newbcast:0 row_mask:0x1 bank_mask:0xf
    v_mov_b32_dpp v29, v27 row_newbcast:2 row_mask:0x2 bank_mask:0xf
    v_mov_b32_dpp v33, v26 row_newbcast:2 row_mask:0x2 bank_mask:0xf
    v_mov_b32_dpp v29, v27 row_newbcast:4 row_mask:0x4 bank_mask:0xf
    v_mov_b32_dpp v33, v26 row_newbcast:4 row_mask:0x4 bank_mask:0xf
    v_mov_b32_dpp v29, v27 row_newbcast:6 row_mask:0x8 bank_mask:0xf
    v_mov_b32_dpp v33, v26 row_newbcast:6 row_mask:0x8 bank_mask:0xf
    v_mov_b32_dpp v30, v25 row_newbcast:1 row_mask:0x1 bank_mask:0xf
    v_mov_b32_dpp v34, v24 row_newbcast:1 row_mask:0x1 bank_mask:0xf
    v_mov_b32_dpp v30, v25 row_newbcast:3 row_mask:0x2 bank_mask:0xf
    v_mov_b32_dpp v34, v24 row_newbcast:3 row_mask:0x2 bank_mask:0xf
    v_mov_b32_dpp v30, v25 row_newbcast:5 row_mask:0x4 bank_mask:0xf
    v_mov_b32_dpp v34, v24 row_newbcast:5 row_mask:0x4 bank_mask:0xf
    v_mov_b32_dpp v30, v25 row_newbcast:7 row_mask:0x8 bank_mask:0xf
    v_mov_b32_dpp v34, v24 row_newbcast:7 row_mask:0x8 bank_mask:0xf
    v_mov_b32_dpp v31, v27 row_newbcast:1 row_mask:0x1 bank_mask:0xf
    v_mov_b32_dpp v35, v26 row_newbcast:1 row_mask:0x1 bank_mask:0xf
    v_mov_b32_dpp v31, v27 row_newbcast:3 row_mask:0x2 bank_mask:0xf
    v_mov_b32_dpp v35, v26 row_newbcast:3 row_mask:0x2 bank_mask:0xf
    v_mov_b32_dpp v31, v27 row_newbcast:5 row_mask:0x4 bank_mask:0xf
    v_mov_b32_dpp v35, v26 row_newbcast:5 row_mask:0x4 bank_mask:0xf
    v_mov_b32_dpp v31, v27 row_newbcast:7 row_mask:0x8 bank_mask:0xf
    v_mov_b32_dpp v35, v26 row_newbcast:7 row_mask:0x8 bank_mask:0xf
    v_pk_fma_f32 v[84:85], v[64:65], v[28:29], v[32:33] neg_lo:[0,0,1] neg_hi:[0,0,1]
    v_pk_fma_f32 v[86:87], v[66:67], v[30:31], v[34:35] neg_lo:[0,0,1] neg_hi:[0,0,1]

    v_pk_fma_f32 v[88:89], v[68:69], v[28:29], v[32:33] neg_lo:[0,0,1] neg_hi:[0,0,1]
    v_pk_fma_f32 v[90:91], v[70:71], v[30:31], v[34:35] neg_lo:[0,0,1] neg_hi:[0,0,1]

    v_pk_fma_f32 v[92:93], v[72:73], v[28:29], v[32:33] neg_lo:[0,0,1] neg_hi:[0,0,1]
    v_pk_fma_f32 v[94:95], v[74:75], v[30:31], v[34:35] neg_lo:[0,0,1] neg_hi:[0,0,1]

    v_pk_fma_f32 v[96:97], v[76:77], v[28:29], v[32:33] neg_lo:[0,0,1] neg_hi:[0,0,1]
    v_pk_fma_f32 v[98:99], v[78:79], v[30:31], v[34:35] neg_lo:[0,0,1] neg_hi:[0,0,1]

    v_pk_fma_f32 v[100:101], v[80:81], v[28:29], v[32:33] neg_lo:[0,0,1] neg_hi:[0,0,1]
    v_pk_fma_f32 v[102:103], v[82:83], v[30:31], v[34:35] neg_lo:[0,0,1] neg_hi:[0,0,1]

    v_cvt_pk_bf16_f32 v48, v84, v85
    v_cvt_pk_bf16_f32 v49, v86, v87
    v_cvt_pk_bf16_f32 v50, v88, v89
    v_cvt_pk_bf16_f32 v51, v90, v91
    v_cvt_pk_bf16_f32 v52, v92, v93
    v_cvt_pk_bf16_f32 v53, v94, v95
    v_cvt_pk_bf16_f32 v54, v96, v97
    v_cvt_pk_bf16_f32 v55, v98, v99
    v_cvt_pk_bf16_f32 v56, v100, v101
    v_cvt_pk_bf16_f32 v57, v102, v103
    s_nop 1
    v_permlane16_swap_b32 v48, v50
    v_permlane16_swap_b32 v49, v51
    v_permlane16_swap_b32 v52, v54
    v_permlane16_swap_b32 v53, v55
    v_permlane16_swap_b32 v56, v58
    v_permlane16_swap_b32 v57, v59
    buffer_store_dwordx4 v[48:51], v22, s[40:43], s66 offen offset:0 sc1
    buffer_store_dwordx4 v[52:55], v22, s[40:43], s66 offen offset:2048 sc1
    buffer_store_dwordx4 v[56:59], v23, s[40:43], s66 offen sc1
    s_waitcnt vmcnt(0)
    s_barrier
    s_add_u32 s36, s8, 0x980000
    s_addc_u32 s37, s9, 0
    s_mov_b32 s38, 0x10000
    s_mov_b32 s39, 0x00020000
    s_lshl_b32 s49, s2, 8
    v_mov_b32 v2, 0
    v_mov_b32 v3, 2
    v_cmp_eq_u32 vcc, 0, v0
    s_and_saveexec_b64 s[62:63], vcc
    s_cbranch_execz L_pub2
    buffer_store_dword v3, v2, s[36:39], s49 offen sc1

L_pub2:
    s_mov_b64 exec, s[62:63]
    s_add_u32 m0, s96, 0xc000
    s_nop 0
    buffer_load_dwordx4 v244, s[92:95], s90 offen offset:0 lds
    buffer_load_dwordx4 v245, s[92:95], s90 offen offset:1024 lds
    buffer_load_dwordx4 v246, s[92:95], s90 offen offset:2048 lds
    buffer_load_dwordx4 v247, s[92:95], s90 offen offset:3072 lds
    s_add_u32 s90, s90, 0x18000
    s_cmp_ge_u32 s90, s91
    s_cselect_b32 s3, 0x180000, 0
    s_sub_u32 s90, s90, s3
    s_add_u32 m0, s96, 0x10000
    s_nop 0
    buffer_load_dwordx4 v244, s[92:95], s90 offen offset:0 lds
    buffer_load_dwordx4 v245, s[92:95], s90 offen offset:1024 lds
    buffer_load_dwordx4 v246, s[92:95], s90 offen offset:2048 lds
    buffer_load_dwordx4 v247, s[92:95], s90 offen offset:3072 lds
    s_add_u32 s90, s90, 0x18000
    s_cmp_ge_u32 s90, s91
    s_cselect_b32 s3, 0x180000, 0
    s_sub_u32 s90, s90, s3
    s_add_u32 m0, s96, 0x14000
    s_nop 0
    buffer_load_dwordx4 v244, s[92:95], s90 offen offset:0 lds
    buffer_load_dwordx4 v245, s[92:95], s90 offen offset:1024 lds
    buffer_load_dwordx4 v246, s[92:95], s90 offen offset:2048 lds
    buffer_load_dwordx4 v247, s[92:95], s90 offen offset:3072 lds
    s_add_u32 s90, s90, 0x18000
    s_cmp_ge_u32 s90, s91
    s_cselect_b32 s3, 0x180000, 0
    s_sub_u32 s90, s90, s3
    s_add_u32 m0, s96, 0x18000
    s_nop 0
    buffer_load_dwordx4 v244, s[92:95], s90 offen offset:0 lds
    buffer_load_dwordx4 v245, s[92:95], s90 offen offset:1024 lds
    buffer_load_dwordx4 v246, s[92:95], s90 offen offset:2048 lds
    buffer_load_dwordx4 v247, s[92:95], s90 offen offset:3072 lds
    s_add_u32 s90, s90, 0x18000
    s_cmp_ge_u32 s90, s91
    s_cselect_b32 s3, 0x180000, 0
    s_sub_u32 s90, s90, s3
    s_add_u32 m0, s96, 0x1c000
    s_nop 0
    buffer_load_dwordx4 v244, s[92:95], s90 offen offset:0 lds
    buffer_load_dwordx4 v245, s[92:95], s90 offen offset:1024 lds
    buffer_load_dwordx4 v246, s[92:95], s90 offen offset:2048 lds
    buffer_load_dwordx4 v247, s[92:95], s90 offen offset:3072 lds
    s_add_u32 s90, s90, 0x18000
    s_cmp_ge_u32 s90, s91
    s_cselect_b32 s3, 0x180000, 0
    s_sub_u32 s90, s90, s3
    s_add_u32 m0, s96, 0x20000
    s_nop 0
    buffer_load_dwordx4 v244, s[92:95], s90 offen offset:0 lds
    buffer_load_dwordx4 v245, s[92:95], s90 offen offset:1024 lds
    buffer_load_dwordx4 v246, s[92:95], s90 offen offset:2048 lds
    buffer_load_dwordx4 v247, s[92:95], s90 offen offset:3072 lds
    s_add_u32 s90, s90, 0x18000
    s_cmp_ge_u32 s90, s91
    s_cselect_b32 s3, 0x180000, 0
    s_sub_u32 s90, s90, s3
    s_add_u32 m0, s96, 0x24000
    s_nop 0
    buffer_load_dwordx4 v244, s[92:95], s90 offen offset:0 lds
    buffer_load_dwordx4 v245, s[92:95], s90 offen offset:1024 lds
    buffer_load_dwordx4 v246, s[92:95], s90 offen offset:2048 lds
    buffer_load_dwordx4 v247, s[92:95], s90 offen offset:3072 lds
    s_add_u32 s90, s90, 0x18000
    s_cmp_ge_u32 s90, s91
    s_cselect_b32 s3, 0x180000, 0
    s_sub_u32 s90, s90, s3
    s_lshr_b32 s49, s51, 2
    s_lshr_b32 s54, s50, 1
    s_lshl_b32 s54, s54, 3
    s_add_u32 s49, s49, s54
    s_mul_i32 s46, s44, 0x180000
    s_lshl_b32 s49, s49, 7
    s_add_u32 s46, s46, s49
    s_and_b32 s48, s51, 3
    s_mul_i32 s48, s48, 3
    s_lshr_b32 s49, s51, 2
    s_mul_i32 s49, s49, 3
    s_lshr_b32 s49, s49, 1
    s_add_u32 s48, s48, s49
    s_add_u32 s48, s48, s50
    s_mul_i32 s49, s48, 43
    s_lshr_b32 s49, s49, 9
    s_mul_i32 s49, s49, 12
    s_sub_u32 s48, s48, s49

    s_add_u32 s65, s46, 0x180000
    s_mul_i32 s3, s48, 0x20000
    s_add_u32 s46, s46, s3
    v_lshrrev_b32 v2, 3, v1
    v_and_b32 v3, 6, v2
    v_and_b32 v4, 7, v1
    v_xor_b32 v3, v3, v4
    v_lshlrev_b32 v3, 4, v3

    s_mov_b32 s49, 4096
    v_mad_u32_u24 v13, v2, s49, v3
    v_add_u32 v14, 0x7c00, v13
    v_add_u32 v15, 0xf800, v13
    v_add_u32 v16, 0x17400, v13
    s_mov_b32 s28, s16
    s_mov_b32 s29, s17
    s_mov_b32 s30, 0x600000
    s_mov_b32 s31, 0x00020000
    s_add_u32 m0, s96, 0x0
    s_nop 0
    buffer_load_dwordx4 v13, s[28:31], s46 offen offset:0 lds
    buffer_load_dwordx4 v14, s[28:31], s46 offen offset:1024 lds
    buffer_load_dwordx4 v15, s[28:31], s46 offen offset:2048 lds
    buffer_load_dwordx4 v16, s[28:31], s46 offen offset:3072 lds
    s_add_u32 s46, s46, 0x20000
    s_cmp_ge_u32 s46, s65
    s_cselect_b32 s3, 0x180000, 0
    s_sub_u32 s46, s46, s3
    s_add_u32 m0, s96, 0x4000
    s_nop 0
    buffer_load_dwordx4 v13, s[28:31], s46 offen offset:0 lds
    buffer_load_dwordx4 v14, s[28:31], s46 offen offset:1024 lds
    buffer_load_dwordx4 v15, s[28:31], s46 offen offset:2048 lds
    buffer_load_dwordx4 v16, s[28:31], s46 offen offset:3072 lds
    s_add_u32 s46, s46, 0x20000
    s_cmp_ge_u32 s46, s65
    s_cselect_b32 s3, 0x180000, 0
    s_sub_u32 s46, s46, s3
    s_add_u32 m0, s96, 0x8000
    s_nop 0
    buffer_load_dwordx4 v13, s[28:31], s46 offen offset:0 lds
    buffer_load_dwordx4 v14, s[28:31], s46 offen offset:1024 lds
    buffer_load_dwordx4 v15, s[28:31], s46 offen offset:2048 lds
    buffer_load_dwordx4 v16, s[28:31], s46 offen offset:3072 lds
    s_add_u32 s46, s46, 0x20000
    s_cmp_ge_u32 s46, s65
    s_cselect_b32 s3, 0x180000, 0
    s_sub_u32 s46, s46, s3
    s_cmp_ge_u32 s2, 240
    s_cbranch_scc1 L_c_idle
    s_mov_b32 s52, s88
    s_mov_b32 s53, s97
    s_mul_i32 s45, s44, 0xa0000
    s_lshl_b32 s49, s53, 12
    s_add_u32 s45, s45, s49
    s_lshl_b32 s57, s52, 7

    s_add_u32 s64, s45, 0xa0000
    s_mul_i32 s3, s89, 0xa000
    s_add_u32 s45, s45, s3
    s_mov_b32 s32, s14
    s_mov_b32 s33, s15
    s_mov_b32 s34, 0xc00
    s_mov_b32 s35, 0x00020000
    v_lshrrev_b32 v7, 4, v1
    v_lshlrev_b32 v7, 3, v7
    buffer_load_dwordx2 v[120:121], v7, s[32:35], s57 offen offset:0
    buffer_load_dwordx2 v[122:123], v7, s[32:35], s57 offen offset:32
    buffer_load_dwordx2 v[124:125], v7, s[32:35], s57 offen offset:64
    buffer_load_dwordx2 v[126:127], v7, s[32:35], s57 offen offset:96
    s_add_u32 s24, s8, 0x500000
    s_addc_u32 s25, s9, 0
    s_mov_b32 s26, 0x280000
    s_mov_b32 s27, 0x00020000
    s_add_u32 s49, s44, 0
    s_and_b32 s49, s49, 3
    s_lshl_b32 s49, s49, 10
    v_lshl_add_u32 v8, v1, 4, s49
    s_add_u32 s49, s44, 1
    s_and_b32 s49, s49, 3
    s_lshl_b32 s49, s49, 10
    v_lshl_add_u32 v9, v1, 4, s49
    s_add_u32 s49, s44, 2
    s_and_b32 s49, s49, 3
    s_lshl_b32 s49, s49, 10
    v_lshl_add_u32 v10, v1, 4, s49
    s_add_u32 s49, s44, 3
    s_and_b32 s49, s49, 3
    s_lshl_b32 s49, s49, 10
    v_lshl_add_u32 v11, v1, 4, s49
    v_mov_b32 v56, 0
    v_mov_b32 v57, 0
    v_mov_b32 v58, 0
    v_mov_b32 v59, 0
    v_mov_b32 v60, 0
    v_mov_b32 v61, 0
    v_mov_b32 v62, 0
    v_mov_b32 v63, 0
    v_mov_b32 v64, 0
    v_mov_b32 v65, 0
    v_mov_b32 v66, 0
    v_mov_b32 v67, 0
    v_mov_b32 v68, 0
    v_mov_b32 v69, 0
    v_mov_b32 v70, 0
    v_mov_b32 v71, 0
    v_mov_b32 v72, 0
    v_mov_b32 v73, 0
    v_mov_b32 v74, 0
    v_mov_b32 v75, 0
    v_mov_b32 v76, 0
    v_mov_b32 v77, 0
    v_mov_b32 v78, 0
    v_mov_b32 v79, 0
    v_mov_b32 v80, 0
    v_mov_b32 v81, 0
    v_mov_b32 v82, 0
    v_mov_b32 v83, 0
    v_mov_b32 v84, 0
    v_mov_b32 v85, 0
    v_mov_b32 v86, 0
    v_mov_b32 v87, 0
    v_mov_b32 v88, 0
    v_mov_b32 v89, 0
    v_mov_b32 v90, 0
    v_mov_b32 v91, 0
    v_mov_b32 v92, 0
    v_mov_b32 v93, 0
    v_mov_b32 v94, 0
    v_mov_b32 v95, 0
    v_mov_b32 v96, 0
    v_mov_b32 v97, 0
    v_mov_b32 v98, 0
    v_mov_b32 v99, 0
    v_mov_b32 v100, 0
    v_mov_b32 v101, 0
    v_mov_b32 v102, 0
    v_mov_b32 v103, 0
    v_mov_b32 v104, 0
    v_mov_b32 v105, 0
    v_mov_b32 v106, 0
    v_mov_b32 v107, 0
    v_mov_b32 v108, 0
    v_mov_b32 v109, 0
    v_mov_b32 v110, 0
    v_mov_b32 v111, 0
    v_mov_b32 v112, 0
    v_mov_b32 v113, 0
    v_mov_b32 v114, 0
    v_mov_b32 v115, 0
    v_mov_b32 v116, 0
    v_mov_b32 v117, 0
    v_mov_b32 v118, 0
    v_mov_b32 v119, 0
    s_lshl_b32 s49, s53, 6
    s_mul_i32 s58, s49, 205
    s_lshr_b32 s58, s58, 14
    s_add_u32 s49, s49, 63
    s_mul_i32 s59, s49, 205
    s_lshr_b32 s59, s59, 14
    v_mov_b32 v3, s58
    v_mov_b32 v4, s59
    v_and_b32 v2, 8, v1
    v_cmp_eq_u32 vcc, 0, v2
    v_and_b32 v5, 3, v1
    v_bfe_u32 v2, v1, 2, 1
    v_cndmask_b32 v3, v4, v3, vcc
    v_lshl_add_u32 v3, v5, 3, v3
    s_lshl_b32 s49, s44, 1
    v_add_u32 v2, s49, v2
    v_lshl_add_u32 v2, v3, 3, v2
    v_lshlrev_b32 v2, 8, v2
    v_mov_b32 v3, 2

    s_mov_b32 s67, 0
L_poll_s3:
    buffer_load_dword v255, v2, s[36:39], 0 offen sc1
    s_add_u32 s67, s67, 1
    s_waitcnt vmcnt(0)
    v_cmp_le_u32 vcc, v3, v255
    s_cmp_eq_u64 vcc, -1
    s_cbranch_scc1 L_go_s3
    s_sleep 8
    s_cmp_lt_u32 s67, 262144
    s_cbranch_scc1 L_poll_s3

L_go_s3:
    buffer_load_dwordx4 v[128:131], v8, s[24:27], s45 offen sc1
    buffer_load_dwordx4 v[132:135], v9, s[24:27], s45 offen sc1
    buffer_load_dwordx4 v[136:139], v10, s[24:27], s45 offen sc1
    buffer_load_dwordx4 v[140:143], v11, s[24:27], s45 offen sc1
    s_add_u32 s45, s45, 0xa000
    s_cmp_ge_u32 s45, s64
    s_cselect_b32 s3, 0xa0000, 0
    s_sub_u32 s45, s45, s3
    buffer_load_dwordx4 v[144:147], v8, s[24:27], s45 offen sc1
    buffer_load_dwordx4 v[148:151], v9, s[24:27], s45 offen sc1
    buffer_load_dwordx4 v[152:155], v10, s[24:27], s45 offen sc1
    buffer_load_dwordx4 v[156:159], v11, s[24:27], s45 offen sc1
    s_add_u32 s45, s45, 0xa000
    s_cmp_ge_u32 s45, s64
    s_cselect_b32 s3, 0xa0000, 0
    s_sub_u32 s45, s45, s3
    buffer_load_dwordx4 v[160:163], v8, s[24:27], s45 offen sc1
    buffer_load_dwordx4 v[164:167], v9, s[24:27], s45 offen sc1
    buffer_load_dwordx4 v[168:171], v10, s[24:27], s45 offen sc1
    buffer_load_dwordx4 v[172:175], v11, s[24:27], s45 offen sc1
    s_add_u32 s45, s45, 0xa000
    s_cmp_ge_u32 s45, s64
    s_cselect_b32 s3, 0xa0000, 0
    s_sub_u32 s45, s45, s3
    buffer_load_dwordx4 v[176:179], v8, s[24:27], s45 offen sc1
    buffer_load_dwordx4 v[180:183], v9, s[24:27], s45 offen sc1
    buffer_load_dwordx4 v[184:187], v10, s[24:27], s45 offen sc1
    buffer_load_dwordx4 v[188:191], v11, s[24:27], s45 offen sc1
    s_add_u32 s45, s45, 0xa000
    s_cmp_ge_u32 s45, s64
    s_cselect_b32 s3, 0xa0000, 0
    s_sub_u32 s45, s45, s3
    buffer_load_dwordx4 v[192:195], v8, s[24:27], s45 offen sc1
    buffer_load_dwordx4 v[196:199], v9, s[24:27], s45 offen sc1
    buffer_load_dwordx4 v[200:203], v10, s[24:27], s45 offen sc1
    buffer_load_dwordx4 v[204:207], v11, s[24:27], s45 offen sc1
    s_add_u32 s45, s45, 0xa000
    s_cmp_ge_u32 s45, s64
    s_cselect_b32 s3, 0xa0000, 0
    s_sub_u32 s45, s45, s3
    ds_read_b64_tr_b16 a[144:145], v248 offset:49152
    ds_read_b64_tr_b16 a[146:147], v248 offset:50176
    ds_read_b64_tr_b16 a[148:149], v249 offset:49152
    ds_read_b64_tr_b16 a[150:151], v249 offset:50176
    ds_read_b64_tr_b16 a[152:153], v250 offset:49152
    ds_read_b64_tr_b16 a[154:155], v250 offset:50176
    ds_read_b64_tr_b16 a[156:157], v251 offset:49152
    ds_read_b64_tr_b16 a[158:159], v251 offset:50176
    v_add_u32 v248, 0x10000, v248
    v_add_u32 v249, 0x10000, v249
    v_add_u32 v250, 0x10000, v250
    v_add_u32 v251, 0x10000, v251
    ds_read_b64_tr_b16 a[160:161], v248 offset:0
    ds_read_b64_tr_b16 a[162:163], v248 offset:1024
    ds_read_b64_tr_b16 a[164:165], v249 offset:0
    ds_read_b64_tr_b16 a[166:167], v249 offset:1024
    ds_read_b64_tr_b16 a[168:169], v250 offset:0
    ds_read_b64_tr_b16 a[170:171], v250 offset:1024
    ds_read_b64_tr_b16 a[172:173], v251 offset:0
    ds_read_b64_tr_b16 a[174:175], v251 offset:1024
    ds_read_b64_tr_b16 a[176:177], v248 offset:16384
    ds_read_b64_tr_b16 a[178:179], v248 offset:17408
    ds_read_b64_tr_b16 a[180:181], v249 offset:16384
    ds_read_b64_tr_b16 a[182:183], v249 offset:17408
    ds_read_b64_tr_b16 a[184:185], v250 offset:16384
    ds_read_b64_tr_b16 a[186:187], v250 offset:17408
    ds_read_b64_tr_b16 a[188:189], v251 offset:16384
    ds_read_b64_tr_b16 a[190:191], v251 offset:17408
    ds_read_b64_tr_b16 a[192:193], v248 offset:32768
    ds_read_b64_tr_b16 a[194:195], v248 offset:33792
    ds_read_b64_tr_b16 a[196:197], v249 offset:32768
    ds_read_b64_tr_b16 a[198:199], v249 offset:33792
    ds_read_b64_tr_b16 a[200:201], v250 offset:32768
    ds_read_b64_tr_b16 a[202:203], v250 offset:33792
    ds_read_b64_tr_b16 a[204:205], v251 offset:32768
    ds_read_b64_tr_b16 a[206:207], v251 offset:33792
    ds_read_b64_tr_b16 a[208:209], v248 offset:49152
    ds_read_b64_tr_b16 a[210:211], v248 offset:50176
    ds_read_b64_tr_b16 a[212:213], v249 offset:49152
    ds_read_b64_tr_b16 a[214:215], v249 offset:50176
    ds_read_b64_tr_b16 a[216:217], v250 offset:49152
    ds_read_b64_tr_b16 a[218:219], v250 offset:50176
    ds_read_b64_tr_b16 a[220:221], v251 offset:49152
    ds_read_b64_tr_b16 a[222:223], v251 offset:50176
    v_add_u32 v248, 0x10000, v248
    v_add_u32 v249, 0x10000, v249
    v_add_u32 v250, 0x10000, v250
    v_add_u32 v251, 0x10000, v251
    ds_read_b64_tr_b16 a[224:225], v248 offset:0
    ds_read_b64_tr_b16 a[226:227], v248 offset:1024
    ds_read_b64_tr_b16 a[228:229], v249 offset:0
    ds_read_b64_tr_b16 a[230:231], v249 offset:1024
    ds_read_b64_tr_b16 a[232:233], v250 offset:0
    ds_read_b64_tr_b16 a[234:235], v250 offset:1024
    ds_read_b64_tr_b16 a[236:237], v251 offset:0
    ds_read_b64_tr_b16 a[238:239], v251 offset:1024
    ds_read_b64_tr_b16 a[240:241], v248 offset:16384
    ds_read_b64_tr_b16 a[242:243], v248 offset:17408
    ds_read_b64_tr_b16 a[244:245], v249 offset:16384
    ds_read_b64_tr_b16 a[246:247], v249 offset:17408
    ds_read_b64_tr_b16 a[248:249], v250 offset:16384
    ds_read_b64_tr_b16 a[250:251], v250 offset:17408
    ds_read_b64_tr_b16 a[252:253], v251 offset:16384
    ds_read_b64_tr_b16 a[254:255], v251 offset:17408
    v_subrev_u32 v248, 0x20000, v248
    v_subrev_u32 v249, 0x20000, v249
    v_subrev_u32 v250, 0x20000, v250
    v_subrev_u32 v251, 0x20000, v251
    s_waitcnt lgkmcnt(0)
    s_waitcnt vmcnt(16)
    s_waitcnt lgkmcnt(0)
    v_mfma_f32_16x16x32_bf16 v[56:59], a[0:3], v[128:131], v[56:59]
    buffer_load_dwordx4 v[208:211], v8, s[24:27], s45 offen sc1
    v_mfma_f32_16x16x32_bf16 v[72:75], a[0:3], v[132:135], v[72:75]
    v_mfma_f32_16x16x32_bf16 v[88:91], a[0:3], v[136:139], v[88:91]
    v_mfma_f32_16x16x32_bf16 v[104:107], a[0:3], v[140:143], v[104:107]
    v_mfma_f32_16x16x32_bf16 v[60:63], a[4:7], v[128:131], v[60:63]
    buffer_load_dwordx4 v[212:215], v9, s[24:27], s45 offen sc1
    v_mfma_f32_16x16x32_bf16 v[76:79], a[4:7], v[132:135], v[76:79]
    v_mfma_f32_16x16x32_bf16 v[92:95], a[4:7], v[136:139], v[92:95]
    v_mfma_f32_16x16x32_bf16 v[108:111], a[4:7], v[140:143], v[108:111]
    v_mfma_f32_16x16x32_bf16 v[64:67], a[8:11], v[128:131], v[64:67]
    buffer_load_dwordx4 v[216:219], v10, s[24:27], s45 offen sc1
    v_mfma_f32_16x16x32_bf16 v[80:83], a[8:11], v[132:135], v[80:83]
    v_mfma_f32_16x16x32_bf16 v[96:99], a[8:11], v[136:139], v[96:99]
    v_mfma_f32_16x16x32_bf16 v[112:115], a[8:11], v[140:143], v[112:115]
    v_mfma_f32_16x16x32_bf16 v[68:71], a[12:15], v[128:131], v[68:71]
    buffer_load_dwordx4 v[220:223], v11, s[24:27], s45 offen sc1
    s_add_u32 s45, s45, 0xa000
    s_cmp_ge_u32 s45, s64
    s_cselect_b32 s3, 0xa0000, 0
    s_sub_u32 s45, s45, s3
    v_mfma_f32_16x16x32_bf16 v[84:87], a[12:15], v[132:135], v[84:87]
    s_waitcnt vmcnt(16)
    s_nop 0
    v_mfma_f32_16x16x32_bf16 v[100:103], a[12:15], v[136:139], v[100:103]
    v_mfma_f32_16x16x32_bf16 v[116:119], a[12:15], v[140:143], v[116:119]
    s_waitcnt lgkmcnt(0)
    v_mfma_f32_16x16x32_bf16 v[56:59], a[16:19], v[144:147], v[56:59]
    buffer_load_dwordx4 v[128:131], v8, s[24:27], s45 offen sc1
    v_mfma_f32_16x16x32_bf16 v[72:75], a[16:19], v[148:151], v[72:75]
    v_mfma_f32_16x16x32_bf16 v[88:91], a[16:19], v[152:155], v[88:91]
    buffer_load_dwordx4 v[132:135], v9, s[24:27], s45 offen sc1
    v_mfma_f32_16x16x32_bf16 v[104:107], a[16:19], v[156:159], v[104:107]
    v_mfma_f32_16x16x32_bf16 v[60:63], a[20:23], v[144:147], v[60:63]
    buffer_load_dwordx4 v[136:139], v10, s[24:27], s45 offen sc1
    v_mfma_f32_16x16x32_bf16 v[76:79], a[20:23], v[148:151], v[76:79]
    v_mfma_f32_16x16x32_bf16 v[92:95], a[20:23], v[152:155], v[92:95]
    buffer_load_dwordx4 v[140:143], v11, s[24:27], s45 offen sc1
    s_add_u32 s45, s45, 0xa000
    s_cmp_ge_u32 s45, s64
    s_cselect_b32 s3, 0xa0000, 0
    s_sub_u32 s45, s45, s3
    v_mfma_f32_16x16x32_bf16 v[108:111], a[20:23], v[156:159], v[108:111]
    v_mfma_f32_16x16x32_bf16 v[64:67], a[24:27], v[144:147], v[64:67]
    s_add_u32 m0, s96, 0xc000
    s_nop 0
    buffer_load_dwordx4 v13, s[28:31], s46 offen offset:0 lds
    v_mfma_f32_16x16x32_bf16 v[80:83], a[24:27], v[148:151], v[80:83]
    v_mfma_f32_16x16x32_bf16 v[96:99], a[24:27], v[152:155], v[96:99]
    buffer_load_dwordx4 v14, s[28:31], s46 offen offset:1024 lds
    v_mfma_f32_16x16x32_bf16 v[112:115], a[24:27], v[156:159], v[112:115]
    v_mfma_f32_16x16x32_bf16 v[68:71], a[28:31], v[144:147], v[68:71]
    buffer_load_dwordx4 v15, s[28:31], s46 offen offset:2048 lds
    v_mfma_f32_16x16x32_bf16 v[84:87], a[28:31], v[148:151], v[84:87]
    s_waitcnt vmcnt(19)
    s_nop 0
    v_mfma_f32_16x16x32_bf16 v[100:103], a[28:31], v[152:155], v[100:103]
    buffer_load_dwordx4 v16, s[28:31], s46 offen offset:3072 lds
    s_add_u32 s46, s46, 0x20000
    s_cmp_ge_u32 s46, s65
    s_cselect_b32 s3, 0x180000, 0
    s_sub_u32 s46, s46, s3
    v_mfma_f32_16x16x32_bf16 v[116:119], a[28:31], v[156:159], v[116:119]
    s_waitcnt lgkmcnt(0)
    v_mfma_f32_16x16x32_bf16 v[56:59], a[32:35], v[160:163], v[56:59]
    buffer_load_dwordx4 v[144:147], v8, s[24:27], s45 offen sc1
    v_mfma_f32_16x16x32_bf16 v[72:75], a[32:35], v[164:167], v[72:75]
    v_mfma_f32_16x16x32_bf16 v[88:91], a[32:35], v[168:171], v[88:91]
    buffer_load_dwordx4 v[148:151], v9, s[24:27], s45 offen sc1
    v_mfma_f32_16x16x32_bf16 v[104:107], a[32:35], v[172:175], v[104:107]
    v_mfma_f32_16x16x32_bf16 v[60:63], a[36:39], v[160:163], v[60:63]
    buffer_load_dwordx4 v[152:155], v10, s[24:27], s45 offen sc1
    v_mfma_f32_16x16x32_bf16 v[76:79], a[36:39], v[164:167], v[76:79]
    v_mfma_f32_16x16x32_bf16 v[92:95], a[36:39], v[168:171], v[92:95]
    buffer_load_dwordx4 v[156:159], v11, s[24:27], s45 offen sc1
    s_add_u32 s45, s45, 0xa000
    s_cmp_ge_u32 s45, s64
    s_cselect_b32 s3, 0xa0000, 0
    s_sub_u32 s45, s45, s3
    v_mfma_f32_16x16x32_bf16 v[108:111], a[36:39], v[172:175], v[108:111]
    v_mfma_f32_16x16x32_bf16 v[64:67], a[40:43], v[160:163], v[64:67]
    s_add_u32 m0, s96, 0x10000
    s_nop 0
    buffer_load_dwordx4 v13, s[28:31], s46 offen offset:0 lds
    v_mfma_f32_16x16x32_bf16 v[80:83], a[40:43], v[164:167], v[80:83]
    v_mfma_f32_16x16x32_bf16 v[96:99], a[40:43], v[168:171], v[96:99]
    buffer_load_dwordx4 v14, s[28:31], s46 offen offset:1024 lds
    v_mfma_f32_16x16x32_bf16 v[112:115], a[40:43], v[172:175], v[112:115]
    v_mfma_f32_16x16x32_bf16 v[68:71], a[44:47], v[160:163], v[68:71]
    buffer_load_dwordx4 v15, s[28:31], s46 offen offset:2048 lds
    v_mfma_f32_16x16x32_bf16 v[84:87], a[44:47], v[164:167], v[84:87]
    s_waitcnt vmcnt(23)
    s_nop 0
    v_mfma_f32_16x16x32_bf16 v[100:103], a[44:47], v[168:171], v[100:103]
    buffer_load_dwordx4 v16, s[28:31], s46 offen offset:3072 lds
    s_add_u32 s46, s46, 0x20000
    s_cmp_ge_u32 s46, s65
    s_cselect_b32 s3, 0x180000, 0
    s_sub_u32 s46, s46, s3
    v_mfma_f32_16x16x32_bf16 v[116:119], a[44:47], v[172:175], v[116:119]
    s_waitcnt lgkmcnt(0)
    v_mfma_f32_16x16x32_bf16 v[56:59], a[48:51], v[176:179], v[56:59]
    buffer_load_dwordx4 v[160:163], v8, s[24:27], s45 offen sc1
    v_mfma_f32_16x16x32_bf16 v[72:75], a[48:51], v[180:183], v[72:75]
    v_mfma_f32_16x16x32_bf16 v[88:91], a[48:51], v[184:187], v[88:91]
    buffer_load_dwordx4 v[164:167], v9, s[24:27], s45 offen sc1
    v_mfma_f32_16x16x32_bf16 v[104:107], a[48:51], v[188:191], v[104:107]
    v_mfma_f32_16x16x32_bf16 v[60:63], a[52:55], v[176:179], v[60:63]
    buffer_load_dwordx4 v[168:171], v10, s[24:27], s45 offen sc1
    v_mfma_f32_16x16x32_bf16 v[76:79], a[52:55], v[180:183], v[76:79]
    v_mfma_f32_16x16x32_bf16 v[92:95], a[52:55], v[184:187], v[92:95]
    buffer_load_dwordx4 v[172:175], v11, s[24:27], s45 offen sc1
    s_add_u32 s45, s45, 0xa000
    s_cmp_ge_u32 s45, s64
    s_cselect_b32 s3, 0xa0000, 0
    s_sub_u32 s45, s45, s3
    v_mfma_f32_16x16x32_bf16 v[108:111], a[52:55], v[188:191], v[108:111]
    v_mfma_f32_16x16x32_bf16 v[64:67], a[56:59], v[176:179], v[64:67]
    s_add_u32 m0, s96, 0x14000
    s_nop 0
    buffer_load_dwordx4 v13, s[28:31], s46 offen offset:0 lds
    v_mfma_f32_16x16x32_bf16 v[80:83], a[56:59], v[180:183], v[80:83]
    v_mfma_f32_16x16x32_bf16 v[96:99], a[56:59], v[184:187], v[96:99]
    buffer_load_dwordx4 v14, s[28:31], s46 offen offset:1024 lds
    v_mfma_f32_16x16x32_bf16 v[112:115], a[56:59], v[188:191], v[112:115]
    v_mfma_f32_16x16x32_bf16 v[68:71], a[60:63], v[176:179], v[68:71]
    buffer_load_dwordx4 v15, s[28:31], s46 offen offset:2048 lds
    v_mfma_f32_16x16x32_bf16 v[84:87], a[60:63], v[180:183], v[84:87]
    s_waitcnt vmcnt(27)
    s_nop 0
    v_mfma_f32_16x16x32_bf16 v[100:103], a[60:63], v[184:187], v[100:103]
    buffer_load_dwordx4 v16, s[28:31], s46 offen offset:3072 lds
    s_add_u32 s46, s46, 0x20000
    s_cmp_ge_u32 s46, s65
    s_cselect_b32 s3, 0x180000, 0
    s_sub_u32 s46, s46, s3
    v_mfma_f32_16x16x32_bf16 v[116:119], a[60:63], v[188:191], v[116:119]
    s_waitcnt lgkmcnt(0)
    v_mfma_f32_16x16x32_bf16 v[56:59], a[64:67], v[192:195], v[56:59]
    buffer_load_dwordx4 v[176:179], v8, s[24:27], s45 offen sc1
    v_mfma_f32_16x16x32_bf16 v[72:75], a[64:67], v[196:199], v[72:75]
    v_mfma_f32_16x16x32_bf16 v[88:91], a[64:67], v[200:203], v[88:91]
    v_mfma_f32_16x16x32_bf16 v[104:107], a[64:67], v[204:207], v[104:107]
    v_mfma_f32_16x16x32_bf16 v[60:63], a[68:71], v[192:195], v[60:63]
    buffer_load_dwordx4 v[180:183], v9, s[24:27], s45 offen sc1
    v_mfma_f32_16x16x32_bf16 v[76:79], a[68:71], v[196:199], v[76:79]
    v_mfma_f32_16x16x32_bf16 v[92:95], a[68:71], v[200:203], v[92:95]
    v_mfma_f32_16x16x32_bf16 v[108:111], a[68:71], v[204:207], v[108:111]
    v_mfma_f32_16x16x32_bf16 v[64:67], a[72:75], v[192:195], v[64:67]
    buffer_load_dwordx4 v[184:187], v10, s[24:27], s45 offen sc1
    v_mfma_f32_16x16x32_bf16 v[80:83], a[72:75], v[196:199], v[80:83]
    v_mfma_f32_16x16x32_bf16 v[96:99], a[72:75], v[200:203], v[96:99]
    v_mfma_f32_16x16x32_bf16 v[112:115], a[72:75], v[204:207], v[112:115]
    v_mfma_f32_16x16x32_bf16 v[68:71], a[76:79], v[192:195], v[68:71]
    buffer_load_dwordx4 v[188:191], v11, s[24:27], s45 offen sc1
    s_add_u32 s45, s45, 0xa000
    s_cmp_ge_u32 s45, s64
    s_cselect_b32 s3, 0xa0000, 0
    s_sub_u32 s45, s45, s3
    v_mfma_f32_16x16x32_bf16 v[84:87], a[76:79], v[196:199], v[84:87]
    s_waitcnt vmcnt(28)
    s_nop 0
    v_mfma_f32_16x16x32_bf16 v[100:103], a[76:79], v[200:203], v[100:103]
    v_mfma_f32_16x16x32_bf16 v[116:119], a[76:79], v[204:207], v[116:119]
    s_waitcnt lgkmcnt(0)
    v_mfma_f32_16x16x32_bf16 v[56:59], a[80:83], v[208:211], v[56:59]
    buffer_load_dwordx4 v[192:195], v8, s[24:27], s45 offen sc1
    v_mfma_f32_16x16x32_bf16 v[72:75], a[80:83], v[212:215], v[72:75]
    v_mfma_f32_16x16x32_bf16 v[88:91], a[80:83], v[216:219], v[88:91]
    v_mfma_f32_16x16x32_bf16 v[104:107], a[80:83], v[220:223], v[104:107]
    v_mfma_f32_16x16x32_bf16 v[60:63], a[84:87], v[208:211], v[60:63]
    buffer_load_dwordx4 v[196:199], v9, s[24:27], s45 offen sc1
    v_mfma_f32_16x16x32_bf16 v[76:79], a[84:87], v[212:215], v[76:79]
    v_mfma_f32_16x16x32_bf16 v[92:95], a[84:87], v[216:219], v[92:95]
    v_mfma_f32_16x16x32_bf16 v[108:111], a[84:87], v[220:223], v[108:111]
    v_mfma_f32_16x16x32_bf16 v[64:67], a[88:91], v[208:211], v[64:67]
    buffer_load_dwordx4 v[200:203], v10, s[24:27], s45 offen sc1
    v_mfma_f32_16x16x32_bf16 v[80:83], a[88:91], v[212:215], v[80:83]
    v_mfma_f32_16x16x32_bf16 v[96:99], a[88:91], v[216:219], v[96:99]
    v_mfma_f32_16x16x32_bf16 v[112:115], a[88:91], v[220:223], v[112:115]
    v_mfma_f32_16x16x32_bf16 v[68:71], a[92:95], v[208:211], v[68:71]
    buffer_load_dwordx4 v[204:207], v11, s[24:27], s45 offen sc1
    s_add_u32 s45, s45, 0xa000
    s_cmp_ge_u32 s45, s64
    s_cselect_b32 s3, 0xa0000, 0
    s_sub_u32 s45, s45, s3
    v_mfma_f32_16x16x32_bf16 v[84:87], a[92:95], v[212:215], v[84:87]
    s_waitcnt vmcnt(28)
    s_nop 0
    v_mfma_f32_16x16x32_bf16 v[100:103], a[92:95], v[216:219], v[100:103]
    v_mfma_f32_16x16x32_bf16 v[116:119], a[92:95], v[220:223], v[116:119]
    s_waitcnt lgkmcnt(0)
    v_mfma_f32_16x16x32_bf16 v[56:59], a[96:99], v[128:131], v[56:59]
    buffer_load_dwordx4 v[208:211], v8, s[24:27], s45 offen sc1
    v_mfma_f32_16x16x32_bf16 v[72:75], a[96:99], v[132:135], v[72:75]
    v_mfma_f32_16x16x32_bf16 v[88:91], a[96:99], v[136:139], v[88:91]
    v_mfma_f32_16x16x32_bf16 v[104:107], a[96:99], v[140:143], v[104:107]
    v_mfma_f32_16x16x32_bf16 v[60:63], a[100:103], v[128:131], v[60:63]
    buffer_load_dwordx4 v[212:215], v9, s[24:27], s45 offen sc1
    v_mfma_f32_16x16x32_bf16 v[76:79], a[100:103], v[132:135], v[76:79]
    v_mfma_f32_16x16x32_bf16 v[92:95], a[100:103], v[136:139], v[92:95]
    v_mfma_f32_16x16x32_bf16 v[108:111], a[100:103], v[140:143], v[108:111]
    v_mfma_f32_16x16x32_bf16 v[64:67], a[104:107], v[128:131], v[64:67]
    buffer_load_dwordx4 v[216:219], v10, s[24:27], s45 offen sc1
    v_mfma_f32_16x16x32_bf16 v[80:83], a[104:107], v[132:135], v[80:83]
    v_mfma_f32_16x16x32_bf16 v[96:99], a[104:107], v[136:139], v[96:99]
    v_mfma_f32_16x16x32_bf16 v[112:115], a[104:107], v[140:143], v[112:115]
    v_mfma_f32_16x16x32_bf16 v[68:71], a[108:111], v[128:131], v[68:71]
    buffer_load_dwordx4 v[220:223], v11, s[24:27], s45 offen sc1
    s_add_u32 s45, s45, 0xa000
    s_cmp_ge_u32 s45, s64
    s_cselect_b32 s3, 0xa0000, 0
    s_sub_u32 s45, s45, s3
    v_mfma_f32_16x16x32_bf16 v[84:87], a[108:111], v[132:135], v[84:87]
    s_waitcnt vmcnt(24)
    s_nop 0
    v_mfma_f32_16x16x32_bf16 v[100:103], a[108:111], v[136:139], v[100:103]
    v_mfma_f32_16x16x32_bf16 v[116:119], a[108:111], v[140:143], v[116:119]
    s_waitcnt lgkmcnt(0)
    v_mfma_f32_16x16x32_bf16 v[56:59], a[112:115], v[144:147], v[56:59]
    buffer_load_dwordx4 v[128:131], v8, s[24:27], s45 offen sc1
    v_mfma_f32_16x16x32_bf16 v[72:75], a[112:115], v[148:151], v[72:75]
    v_mfma_f32_16x16x32_bf16 v[88:91], a[112:115], v[152:155], v[88:91]
    v_mfma_f32_16x16x32_bf16 v[104:107], a[112:115], v[156:159], v[104:107]
    v_mfma_f32_16x16x32_bf16 v[60:63], a[116:119], v[144:147], v[60:63]
    buffer_load_dwordx4 v[132:135], v9, s[24:27], s45 offen sc1
    v_mfma_f32_16x16x32_bf16 v[76:79], a[116:119], v[148:151], v[76:79]
    v_mfma_f32_16x16x32_bf16 v[92:95], a[116:119], v[152:155], v[92:95]
    v_mfma_f32_16x16x32_bf16 v[108:111], a[116:119], v[156:159], v[108:111]
    v_mfma_f32_16x16x32_bf16 v[64:67], a[120:123], v[144:147], v[64:67]
    buffer_load_dwordx4 v[136:139], v10, s[24:27], s45 offen sc1
    v_mfma_f32_16x16x32_bf16 v[80:83], a[120:123], v[148:151], v[80:83]
    v_mfma_f32_16x16x32_bf16 v[96:99], a[120:123], v[152:155], v[96:99]
    v_mfma_f32_16x16x32_bf16 v[112:115], a[120:123], v[156:159], v[112:115]
    v_mfma_f32_16x16x32_bf16 v[68:71], a[124:127], v[144:147], v[68:71]
    buffer_load_dwordx4 v[140:143], v11, s[24:27], s45 offen sc1
    s_add_u32 s45, s45, 0xa000
    s_cmp_ge_u32 s45, s64
    s_cselect_b32 s3, 0xa0000, 0
    s_sub_u32 s45, s45, s3
    v_mfma_f32_16x16x32_bf16 v[84:87], a[124:127], v[148:151], v[84:87]
    s_waitcnt vmcnt(20)
    s_nop 0
    v_mfma_f32_16x16x32_bf16 v[100:103], a[124:127], v[152:155], v[100:103]
    v_mfma_f32_16x16x32_bf16 v[116:119], a[124:127], v[156:159], v[116:119]
    s_waitcnt lgkmcnt(0)
    v_mfma_f32_16x16x32_bf16 v[56:59], a[128:131], v[160:163], v[56:59]
    buffer_load_dwordx4 v[144:147], v8, s[24:27], s45 offen sc1
    v_mfma_f32_16x16x32_bf16 v[72:75], a[128:131], v[164:167], v[72:75]
    v_mfma_f32_16x16x32_bf16 v[88:91], a[128:131], v[168:171], v[88:91]
    v_mfma_f32_16x16x32_bf16 v[104:107], a[128:131], v[172:175], v[104:107]
    v_mfma_f32_16x16x32_bf16 v[60:63], a[132:135], v[160:163], v[60:63]
    buffer_load_dwordx4 v[148:151], v9, s[24:27], s45 offen sc1
    v_mfma_f32_16x16x32_bf16 v[76:79], a[132:135], v[164:167], v[76:79]
    v_mfma_f32_16x16x32_bf16 v[92:95], a[132:135], v[168:171], v[92:95]
    v_mfma_f32_16x16x32_bf16 v[108:111], a[132:135], v[172:175], v[108:111]
    v_mfma_f32_16x16x32_bf16 v[64:67], a[136:139], v[160:163], v[64:67]
    buffer_load_dwordx4 v[152:155], v10, s[24:27], s45 offen sc1
    v_mfma_f32_16x16x32_bf16 v[80:83], a[136:139], v[164:167], v[80:83]
    v_mfma_f32_16x16x32_bf16 v[96:99], a[136:139], v[168:171], v[96:99]
    v_mfma_f32_16x16x32_bf16 v[112:115], a[136:139], v[172:175], v[112:115]
    v_mfma_f32_16x16x32_bf16 v[68:71], a[140:143], v[160:163], v[68:71]
    buffer_load_dwordx4 v[156:159], v11, s[24:27], s45 offen sc1
    s_add_u32 s45, s45, 0xa000
    s_cmp_ge_u32 s45, s64
    s_cselect_b32 s3, 0xa0000, 0
    s_sub_u32 s45, s45, s3
    v_mfma_f32_16x16x32_bf16 v[84:87], a[140:143], v[164:167], v[84:87]
    s_waitcnt vmcnt(16)
    s_nop 0
    v_mfma_f32_16x16x32_bf16 v[100:103], a[140:143], v[168:171], v[100:103]
    v_mfma_f32_16x16x32_bf16 v[116:119], a[140:143], v[172:175], v[116:119]
    s_waitcnt lgkmcnt(0)
    v_mfma_f32_16x16x32_bf16 v[56:59], a[144:147], v[176:179], v[56:59]
    buffer_load_dwordx4 v[160:163], v8, s[24:27], s45 offen sc1
    v_mfma_f32_16x16x32_bf16 v[72:75], a[144:147], v[180:183], v[72:75]
    v_mfma_f32_16x16x32_bf16 v[88:91], a[144:147], v[184:187], v[88:91]
    v_mfma_f32_16x16x32_bf16 v[104:107], a[144:147], v[188:191], v[104:107]
    v_mfma_f32_16x16x32_bf16 v[60:63], a[148:151], v[176:179], v[60:63]
    buffer_load_dwordx4 v[164:167], v9, s[24:27], s45 offen sc1
    v_mfma_f32_16x16x32_bf16 v[76:79], a[148:151], v[180:183], v[76:79]
    v_mfma_f32_16x16x32_bf16 v[92:95], a[148:151], v[184:187], v[92:95]
    v_mfma_f32_16x16x32_bf16 v[108:111], a[148:151], v[188:191], v[108:111]
    v_mfma_f32_16x16x32_bf16 v[64:67], a[152:155], v[176:179], v[64:67]
    buffer_load_dwordx4 v[168:171], v10, s[24:27], s45 offen sc1
    v_mfma_f32_16x16x32_bf16 v[80:83], a[152:155], v[180:183], v[80:83]
    v_mfma_f32_16x16x32_bf16 v[96:99], a[152:155], v[184:187], v[96:99]
    v_mfma_f32_16x16x32_bf16 v[112:115], a[152:155], v[188:191], v[112:115]
    v_mfma_f32_16x16x32_bf16 v[68:71], a[156:159], v[176:179], v[68:71]
    buffer_load_dwordx4 v[172:175], v11, s[24:27], s45 offen sc1
    s_add_u32 s45, s45, 0xa000
    s_cmp_ge_u32 s45, s64
    s_cselect_b32 s3, 0xa0000, 0
    s_sub_u32 s45, s45, s3
    v_mfma_f32_16x16x32_bf16 v[84:87], a[156:159], v[180:183], v[84:87]
    s_waitcnt vmcnt(16)
    s_nop 0
    v_mfma_f32_16x16x32_bf16 v[100:103], a[156:159], v[184:187], v[100:103]
    v_mfma_f32_16x16x32_bf16 v[116:119], a[156:159], v[188:191], v[116:119]
    s_waitcnt lgkmcnt(0)
    v_mfma_f32_16x16x32_bf16 v[56:59], a[160:163], v[192:195], v[56:59]
    buffer_load_dwordx4 v[176:179], v8, s[24:27], s45 offen sc1
    v_mfma_f32_16x16x32_bf16 v[72:75], a[160:163], v[196:199], v[72:75]
    v_mfma_f32_16x16x32_bf16 v[88:91], a[160:163], v[200:203], v[88:91]
    v_mfma_f32_16x16x32_bf16 v[104:107], a[160:163], v[204:207], v[104:107]
    v_mfma_f32_16x16x32_bf16 v[60:63], a[164:167], v[192:195], v[60:63]
    buffer_load_dwordx4 v[180:183], v9, s[24:27], s45 offen sc1
    v_mfma_f32_16x16x32_bf16 v[76:79], a[164:167], v[196:199], v[76:79]
    v_mfma_f32_16x16x32_bf16 v[92:95], a[164:167], v[200:203], v[92:95]
    v_mfma_f32_16x16x32_bf16 v[108:111], a[164:167], v[204:207], v[108:111]
    v_mfma_f32_16x16x32_bf16 v[64:67], a[168:171], v[192:195], v[64:67]
    buffer_load_dwordx4 v[184:187], v10, s[24:27], s45 offen sc1
    v_mfma_f32_16x16x32_bf16 v[80:83], a[168:171], v[196:199], v[80:83]
    v_mfma_f32_16x16x32_bf16 v[96:99], a[168:171], v[200:203], v[96:99]
    v_mfma_f32_16x16x32_bf16 v[112:115], a[168:171], v[204:207], v[112:115]
    v_mfma_f32_16x16x32_bf16 v[68:71], a[172:175], v[192:195], v[68:71]
    buffer_load_dwordx4 v[188:191], v11, s[24:27], s45 offen sc1
    s_add_u32 s45, s45, 0xa000
    s_cmp_ge_u32 s45, s64
    s_cselect_b32 s3, 0xa0000, 0
    s_sub_u32 s45, s45, s3
    v_mfma_f32_16x16x32_bf16 v[84:87], a[172:175], v[196:199], v[84:87]
    s_waitcnt vmcnt(16)
    s_nop 0
    v_mfma_f32_16x16x32_bf16 v[100:103], a[172:175], v[200:203], v[100:103]
    v_mfma_f32_16x16x32_bf16 v[116:119], a[172:175], v[204:207], v[116:119]
    s_waitcnt lgkmcnt(0)
    v_mfma_f32_16x16x32_bf16 v[56:59], a[176:179], v[208:211], v[56:59]
    v_mfma_f32_16x16x32_bf16 v[72:75], a[176:179], v[212:215], v[72:75]
    v_mfma_f32_16x16x32_bf16 v[88:91], a[176:179], v[216:219], v[88:91]
    v_mfma_f32_16x16x32_bf16 v[104:107], a[176:179], v[220:223], v[104:107]
    v_mfma_f32_16x16x32_bf16 v[60:63], a[180:183], v[208:211], v[60:63]
    v_mfma_f32_16x16x32_bf16 v[76:79], a[180:183], v[212:215], v[76:79]
    v_mfma_f32_16x16x32_bf16 v[92:95], a[180:183], v[216:219], v[92:95]
    v_mfma_f32_16x16x32_bf16 v[108:111], a[180:183], v[220:223], v[108:111]
    v_mfma_f32_16x16x32_bf16 v[64:67], a[184:187], v[208:211], v[64:67]
    v_mfma_f32_16x16x32_bf16 v[80:83], a[184:187], v[212:215], v[80:83]
    v_mfma_f32_16x16x32_bf16 v[96:99], a[184:187], v[216:219], v[96:99]
    v_mfma_f32_16x16x32_bf16 v[112:115], a[184:187], v[220:223], v[112:115]
    v_mfma_f32_16x16x32_bf16 v[68:71], a[188:191], v[208:211], v[68:71]
    v_mfma_f32_16x16x32_bf16 v[84:87], a[188:191], v[212:215], v[84:87]
    s_waitcnt vmcnt(12)
    s_nop 0
    v_mfma_f32_16x16x32_bf16 v[100:103], a[188:191], v[216:219], v[100:103]
    v_mfma_f32_16x16x32_bf16 v[116:119], a[188:191], v[220:223], v[116:119]
    s_waitcnt lgkmcnt(0)
    v_mfma_f32_16x16x32_bf16 v[56:59], a[192:195], v[128:131], v[56:59]
    v_mfma_f32_16x16x32_bf16 v[72:75], a[192:195], v[132:135], v[72:75]
    v_mfma_f32_16x16x32_bf16 v[88:91], a[192:195], v[136:139], v[88:91]
    v_mfma_f32_16x16x32_bf16 v[104:107], a[192:195], v[140:143], v[104:107]
    v_mfma_f32_16x16x32_bf16 v[60:63], a[196:199], v[128:131], v[60:63]
    v_mfma_f32_16x16x32_bf16 v[76:79], a[196:199], v[132:135], v[76:79]
    v_mfma_f32_16x16x32_bf16 v[92:95], a[196:199], v[136:139], v[92:95]
    v_mfma_f32_16x16x32_bf16 v[108:111], a[196:199], v[140:143], v[108:111]
    v_mfma_f32_16x16x32_bf16 v[64:67], a[200:203], v[128:131], v[64:67]
    v_mfma_f32_16x16x32_bf16 v[80:83], a[200:203], v[132:135], v[80:83]
    v_mfma_f32_16x16x32_bf16 v[96:99], a[200:203], v[136:139], v[96:99]
    v_mfma_f32_16x16x32_bf16 v[112:115], a[200:203], v[140:143], v[112:115]
    v_mfma_f32_16x16x32_bf16 v[68:71], a[204:207], v[128:131], v[68:71]
    v_mfma_f32_16x16x32_bf16 v[84:87], a[204:207], v[132:135], v[84:87]
    s_waitcnt vmcnt(8)
    s_nop 0
    v_mfma_f32_16x16x32_bf16 v[100:103], a[204:207], v[136:139], v[100:103]
    v_mfma_f32_16x16x32_bf16 v[116:119], a[204:207], v[140:143], v[116:119]
    s_waitcnt lgkmcnt(0)
    v_mfma_f32_16x16x32_bf16 v[56:59], a[208:211], v[144:147], v[56:59]
    v_mfma_f32_16x16x32_bf16 v[72:75], a[208:211], v[148:151], v[72:75]
    v_mfma_f32_16x16x32_bf16 v[88:91], a[208:211], v[152:155], v[88:91]
    v_mfma_f32_16x16x32_bf16 v[104:107], a[208:211], v[156:159], v[104:107]
    v_mfma_f32_16x16x32_bf16 v[60:63], a[212:215], v[144:147], v[60:63]
    v_mfma_f32_16x16x32_bf16 v[76:79], a[212:215], v[148:151], v[76:79]
    v_mfma_f32_16x16x32_bf16 v[92:95], a[212:215], v[152:155], v[92:95]
    v_mfma_f32_16x16x32_bf16 v[108:111], a[212:215], v[156:159], v[108:111]
    v_mfma_f32_16x16x32_bf16 v[64:67], a[216:219], v[144:147], v[64:67]
    v_mfma_f32_16x16x32_bf16 v[80:83], a[216:219], v[148:151], v[80:83]
    v_mfma_f32_16x16x32_bf16 v[96:99], a[216:219], v[152:155], v[96:99]
    v_mfma_f32_16x16x32_bf16 v[112:115], a[216:219], v[156:159], v[112:115]
    v_mfma_f32_16x16x32_bf16 v[68:71], a[220:223], v[144:147], v[68:71]
    v_mfma_f32_16x16x32_bf16 v[84:87], a[220:223], v[148:151], v[84:87]
    s_waitcnt vmcnt(4)
    s_nop 0
    v_mfma_f32_16x16x32_bf16 v[100:103], a[220:223], v[152:155], v[100:103]
    v_mfma_f32_16x16x32_bf16 v[116:119], a[220:223], v[156:159], v[116:119]
    s_waitcnt lgkmcnt(0)
    v_mfma_f32_16x16x32_bf16 v[56:59], a[224:227], v[160:163], v[56:59]
    v_mfma_f32_16x16x32_bf16 v[72:75], a[224:227], v[164:167], v[72:75]
    v_mfma_f32_16x16x32_bf16 v[88:91], a[224:227], v[168:171], v[88:91]
    v_mfma_f32_16x16x32_bf16 v[104:107], a[224:227], v[172:175], v[104:107]
    v_mfma_f32_16x16x32_bf16 v[60:63], a[228:231], v[160:163], v[60:63]
    v_mfma_f32_16x16x32_bf16 v[76:79], a[228:231], v[164:167], v[76:79]
    v_mfma_f32_16x16x32_bf16 v[92:95], a[228:231], v[168:171], v[92:95]
    v_mfma_f32_16x16x32_bf16 v[108:111], a[228:231], v[172:175], v[108:111]
    v_mfma_f32_16x16x32_bf16 v[64:67], a[232:235], v[160:163], v[64:67]
    v_mfma_f32_16x16x32_bf16 v[80:83], a[232:235], v[164:167], v[80:83]
    v_mfma_f32_16x16x32_bf16 v[96:99], a[232:235], v[168:171], v[96:99]
    v_mfma_f32_16x16x32_bf16 v[112:115], a[232:235], v[172:175], v[112:115]
    v_mfma_f32_16x16x32_bf16 v[68:71], a[236:239], v[160:163], v[68:71]
    v_mfma_f32_16x16x32_bf16 v[84:87], a[236:239], v[164:167], v[84:87]
    s_waitcnt vmcnt(0)
    s_nop 0
    v_mfma_f32_16x16x32_bf16 v[100:103], a[236:239], v[168:171], v[100:103]
    v_mfma_f32_16x16x32_bf16 v[116:119], a[236:239], v[172:175], v[116:119]
    s_waitcnt lgkmcnt(0)
    v_mfma_f32_16x16x32_bf16 v[56:59], a[240:243], v[176:179], v[56:59]
    v_mfma_f32_16x16x32_bf16 v[72:75], a[240:243], v[180:183], v[72:75]
    v_mfma_f32_16x16x32_bf16 v[88:91], a[240:243], v[184:187], v[88:91]
    v_mfma_f32_16x16x32_bf16 v[104:107], a[240:243], v[188:191], v[104:107]
    v_mfma_f32_16x16x32_bf16 v[60:63], a[244:247], v[176:179], v[60:63]
    v_mfma_f32_16x16x32_bf16 v[76:79], a[244:247], v[180:183], v[76:79]
    v_mfma_f32_16x16x32_bf16 v[92:95], a[244:247], v[184:187], v[92:95]
    v_mfma_f32_16x16x32_bf16 v[108:111], a[244:247], v[188:191], v[108:111]
    v_mfma_f32_16x16x32_bf16 v[64:67], a[248:251], v[176:179], v[64:67]
    v_mfma_f32_16x16x32_bf16 v[80:83], a[248:251], v[180:183], v[80:83]
    v_mfma_f32_16x16x32_bf16 v[96:99], a[248:251], v[184:187], v[96:99]
    v_mfma_f32_16x16x32_bf16 v[112:115], a[248:251], v[188:191], v[112:115]
    v_mfma_f32_16x16x32_bf16 v[68:71], a[252:255], v[176:179], v[68:71]
    v_mfma_f32_16x16x32_bf16 v[84:87], a[252:255], v[180:183], v[84:87]
    v_mfma_f32_16x16x32_bf16 v[100:103], a[252:255], v[184:187], v[100:103]
    v_mfma_f32_16x16x32_bf16 v[116:119], a[252:255], v[188:191], v[116:119]
    s_sub_u32 s49, s44, 0
    s_and_b32 s49, s49, 3
    s_mul_i32 s49, s49, 0x3000
    s_add_u32 s49, s49, 0x18000
    v_lshl_add_u32 v2, v1, 4, s49
    s_sub_u32 s49, s44, 1
    s_and_b32 s49, s49, 3
    s_mul_i32 s49, s49, 0x3000
    s_add_u32 s49, s49, 0x18000
    v_lshl_add_u32 v3, v1, 4, s49
    s_sub_u32 s49, s44, 2
    s_and_b32 s49, s49, 3
    s_mul_i32 s49, s49, 0x3000
    s_add_u32 s49, s49, 0x18000
    v_lshl_add_u32 v4, v1, 4, s49
    s_sub_u32 s49, s44, 3
    s_and_b32 s49, s49, 3
    s_mul_i32 s49, s49, 0x3000
    s_add_u32 s49, s49, 0x18000
    v_lshl_add_u32 v5, v1, 4, s49
    s_barrier
    ds_write_b128 v2, v[72:75] offset:0
    ds_write_b128 v2, v[76:79] offset:1024
    ds_write_b128 v2, v[80:83] offset:2048
    ds_write_b128 v2, v[84:87] offset:3072
    ds_write_b128 v2, v[88:91] offset:4096
    ds_write_b128 v2, v[92:95] offset:5120
    ds_write_b128 v2, v[96:99] offset:6144
    ds_write_b128 v2, v[100:103] offset:7168
    ds_write_b128 v2, v[104:107] offset:8192
    ds_write_b128 v2, v[108:111] offset:9216
    ds_write_b128 v2, v[112:115] offset:10240
    ds_write_b128 v2, v[116:119] offset:11264
    s_waitcnt lgkmcnt(0)
    s_barrier
    ds_read_b128 v[72:75], v3 offset:0
    ds_read_b128 v[76:79], v3 offset:1024
    ds_read_b128 v[80:83], v3 offset:2048
    ds_read_b128 v[84:87], v3 offset:3072
    ds_read_b128 v[88:91], v4 offset:4096
    ds_read_b128 v[92:95], v4 offset:5120
    ds_read_b128 v[96:99], v4 offset:6144
    ds_read_b128 v[100:103], v4 offset:7168
    ds_read_b128 v[104:107], v5 offset:8192
    ds_read_b128 v[108:111], v5 offset:9216
    ds_read_b128 v[112:115], v5 offset:10240
    ds_read_b128 v[116:119], v5 offset:11264
    s_waitcnt lgkmcnt(11)
    v_pk_add_f32 v[56:57], v[56:57], v[72:73]
    v_pk_add_f32 v[58:59], v[58:59], v[74:75]
    s_waitcnt lgkmcnt(10)
    v_pk_add_f32 v[60:61], v[60:61], v[76:77]
    v_pk_add_f32 v[62:63], v[62:63], v[78:79]
    s_waitcnt lgkmcnt(9)
    v_pk_add_f32 v[64:65], v[64:65], v[80:81]
    v_pk_add_f32 v[66:67], v[66:67], v[82:83]
    s_waitcnt lgkmcnt(8)
    v_pk_add_f32 v[68:69], v[68:69], v[84:85]
    v_pk_add_f32 v[70:71], v[70:71], v[86:87]
    s_waitcnt lgkmcnt(7)
    v_pk_add_f32 v[56:57], v[56:57], v[88:89]
    v_pk_add_f32 v[58:59], v[58:59], v[90:91]
    s_waitcnt lgkmcnt(6)
    v_pk_add_f32 v[60:61], v[60:61], v[92:93]
    v_pk_add_f32 v[62:63], v[62:63], v[94:95]
    s_waitcnt lgkmcnt(5)
    v_pk_add_f32 v[64:65], v[64:65], v[96:97]
    v_pk_add_f32 v[66:67], v[66:67], v[98:99]
    s_waitcnt lgkmcnt(4)
    v_pk_add_f32 v[68:69], v[68:69], v[100:101]
    v_pk_add_f32 v[70:71], v[70:71], v[102:103]
    s_waitcnt lgkmcnt(3)
    v_pk_add_f32 v[56:57], v[56:57], v[104:105]
    v_pk_add_f32 v[58:59], v[58:59], v[106:107]
    s_waitcnt lgkmcnt(2)
    v_pk_add_f32 v[60:61], v[60:61], v[108:109]
    v_pk_add_f32 v[62:63], v[62:63], v[110:111]
    s_waitcnt lgkmcnt(1)
    v_pk_add_f32 v[64:65], v[64:65], v[112:113]
    v_pk_add_f32 v[66:67], v[66:67], v[114:115]
    s_waitcnt lgkmcnt(0)
    v_pk_add_f32 v[68:69], v[68:69], v[116:117]
    v_pk_add_f32 v[70:71], v[70:71], v[118:119]
    s_mov_b32 s58, 0xc0135761
    s_mov_b32 s59, 0xbdd2d3e8
    v_mov_b32 v40, s58
    s_add_u32 s40, s8, 0x780000
    s_addc_u32 s41, s9, 0
    s_mov_b32 s42, 0x1e0000
    s_mov_b32 s43, 0x00020000
    v_lshlrev_b32 v44, 16, v120
    v_and_b32 v45, 0xffff0000, v120
    v_lshlrev_b32 v46, 16, v121
    v_and_b32 v47, 0xffff0000, v121
    v_pk_add_f32 v[56:57], v[56:57], v[44:45]
    v_pk_add_f32 v[58:59], v[58:59], v[46:47]
    v_pk_mul_f32 v[44:45], v[56:57], v[56:57]
    v_pk_mul_f32 v[46:47], v[58:59], v[58:59]

    v_fma_f32 v44, v44, s59, v40
    v_fma_f32 v45, v45, s59, v40
    v_fma_f32 v46, v46, s59, v40
    v_fma_f32 v47, v47, s59, v40
    v_pk_mul_f32 v[44:45], v[44:45], v[56:57]
    v_pk_mul_f32 v[46:47], v[46:47], v[58:59]
    v_exp_f32 v44, v44
    v_exp_f32 v45, v45
    v_exp_f32 v46, v46
    v_exp_f32 v47, v47
    s_nop 0
    v_add_f32 v44, 1.0, v44
    v_add_f32 v45, 1.0, v45
    v_add_f32 v46, 1.0, v46
    v_add_f32 v47, 1.0, v47
    v_rcp_f32 v44, v44
    v_rcp_f32 v45, v45
    v_rcp_f32 v46, v46
    v_rcp_f32 v47, v47
    s_nop 0
    v_pk_mul_f32 v[44:45], v[44:45], v[56:57]
    v_pk_mul_f32 v[46:47], v[46:47], v[58:59]
    v_cvt_pk_bf16_f32 v24, v44, v45
    v_cvt_pk_bf16_f32 v25, v46, v47
    v_lshlrev_b32 v44, 16, v122
    v_and_b32 v45, 0xffff0000, v122
    v_lshlrev_b32 v46, 16, v123
    v_and_b32 v47, 0xffff0000, v123
    v_pk_add_f32 v[60:61], v[60:61], v[44:45]
    v_pk_add_f32 v[62:63], v[62:63], v[46:47]
    v_pk_mul_f32 v[44:45], v[60:61], v[60:61]
    v_pk_mul_f32 v[46:47], v[62:63], v[62:63]

    v_fma_f32 v44, v44, s59, v40
    v_fma_f32 v45, v45, s59, v40
    v_fma_f32 v46, v46, s59, v40
    v_fma_f32 v47, v47, s59, v40
    v_pk_mul_f32 v[44:45], v[44:45], v[60:61]
    v_pk_mul_f32 v[46:47], v[46:47], v[62:63]
    v_exp_f32 v44, v44
    v_exp_f32 v45, v45
    v_exp_f32 v46, v46
    v_exp_f32 v47, v47
    s_nop 0
    v_add_f32 v44, 1.0, v44
    v_add_f32 v45, 1.0, v45
    v_add_f32 v46, 1.0, v46
    v_add_f32 v47, 1.0, v47
    v_rcp_f32 v44, v44
    v_rcp_f32 v45, v45
    v_rcp_f32 v46, v46
    v_rcp_f32 v47, v47
    s_nop 0
    v_pk_mul_f32 v[44:45], v[44:45], v[60:61]
    v_pk_mul_f32 v[46:47], v[46:47], v[62:63]
    v_cvt_pk_bf16_f32 v26, v44, v45
    v_cvt_pk_bf16_f32 v27, v46, v47
    v_lshlrev_b32 v44, 16, v124
    v_and_b32 v45, 0xffff0000, v124
    v_lshlrev_b32 v46, 16, v125
    v_and_b32 v47, 0xffff0000, v125
    v_pk_add_f32 v[64:65], v[64:65], v[44:45]
    v_pk_add_f32 v[66:67], v[66:67], v[46:47]
    v_pk_mul_f32 v[44:45], v[64:65], v[64:65]
    v_pk_mul_f32 v[46:47], v[66:67], v[66:67]

    v_fma_f32 v44, v44, s59, v40
    v_fma_f32 v45, v45, s59, v40
    v_fma_f32 v46, v46, s59, v40
    v_fma_f32 v47, v47, s59, v40
    v_pk_mul_f32 v[44:45], v[44:45], v[64:65]
    v_pk_mul_f32 v[46:47], v[46:47], v[66:67]
    v_exp_f32 v44, v44
    v_exp_f32 v45, v45
    v_exp_f32 v46, v46
    v_exp_f32 v47, v47
    s_nop 0
    v_add_f32 v44, 1.0, v44
    v_add_f32 v45, 1.0, v45
    v_add_f32 v46, 1.0, v46
    v_add_f32 v47, 1.0, v47
    v_rcp_f32 v44, v44
    v_rcp_f32 v45, v45
    v_rcp_f32 v46, v46
    v_rcp_f32 v47, v47
    s_nop 0
    v_pk_mul_f32 v[44:45], v[44:45], v[64:65]
    v_pk_mul_f32 v[46:47], v[46:47], v[66:67]
    v_cvt_pk_bf16_f32 v28, v44, v45
    v_cvt_pk_bf16_f32 v29, v46, v47
    v_lshlrev_b32 v44, 16, v126
    v_and_b32 v45, 0xffff0000, v126
    v_lshlrev_b32 v46, 16, v127
    v_and_b32 v47, 0xffff0000, v127
    v_pk_add_f32 v[68:69], v[68:69], v[44:45]
    v_pk_add_f32 v[70:71], v[70:71], v[46:47]
    v_pk_mul_f32 v[44:45], v[68:69], v[68:69]
    v_pk_mul_f32 v[46:47], v[70:71], v[70:71]

    v_fma_f32 v44, v44, s59, v40
    v_fma_f32 v45, v45, s59, v40
    v_fma_f32 v46, v46, s59, v40
    v_fma_f32 v47, v47, s59, v40
    v_pk_mul_f32 v[44:45], v[44:45], v[68:69]
    v_pk_mul_f32 v[46:47], v[46:47], v[70:71]
    v_exp_f32 v44, v44
    v_exp_f32 v45, v45
    v_exp_f32 v46, v46
    v_exp_f32 v47, v47
    s_nop 0
    v_add_f32 v44, 1.0, v44
    v_add_f32 v45, 1.0, v45
    v_add_f32 v46, 1.0, v46
    v_add_f32 v47, 1.0, v47
    v_rcp_f32 v44, v44
    v_rcp_f32 v45, v45
    v_rcp_f32 v46, v46
    v_rcp_f32 v47, v47
    s_nop 0
    v_pk_mul_f32 v[44:45], v[44:45], v[68:69]
    v_pk_mul_f32 v[46:47], v[46:47], v[70:71]
    v_cvt_pk_bf16_f32 v30, v44, v45
    v_cvt_pk_bf16_f32 v31, v46, v47
    s_mul_i32 s49, s52, 0x14000
    s_lshl_b32 s60, s53, 2
    s_add_u32 s60, s60, s44
    s_lshl_b32 s60, s60, 10
    s_add_u32 s49, s49, s60
    s_add_u32 s60, s49, 0xa000
    v_lshlrev_b32 v2, 4, v1
    buffer_store_dwordx4 v[24:27], v2, s[40:43], s49 offen sc1
    buffer_store_dwordx4 v[28:31], v2, s[40:43], s60 offen sc1
    s_branch L_c_done

L_c_idle:
    s_waitcnt vmcnt(0)
    s_add_u32 m0, s96, 0xc000
    s_nop 0
    buffer_load_dwordx4 v13, s[28:31], s46 offen offset:0 lds
    buffer_load_dwordx4 v14, s[28:31], s46 offen offset:1024 lds
    buffer_load_dwordx4 v15, s[28:31], s46 offen offset:2048 lds
    buffer_load_dwordx4 v16, s[28:31], s46 offen offset:3072 lds
    s_add_u32 s46, s46, 0x20000
    s_cmp_ge_u32 s46, s65
    s_cselect_b32 s3, 0x180000, 0
    s_sub_u32 s46, s46, s3
    s_add_u32 m0, s96, 0x10000
    s_nop 0
    buffer_load_dwordx4 v13, s[28:31], s46 offen offset:0 lds
    buffer_load_dwordx4 v14, s[28:31], s46 offen offset:1024 lds
    buffer_load_dwordx4 v15, s[28:31], s46 offen offset:2048 lds
    buffer_load_dwordx4 v16, s[28:31], s46 offen offset:3072 lds
    s_add_u32 s46, s46, 0x20000
    s_cmp_ge_u32 s46, s65
    s_cselect_b32 s3, 0x180000, 0
    s_sub_u32 s46, s46, s3
    s_add_u32 m0, s96, 0x14000
    s_nop 0
    buffer_load_dwordx4 v13, s[28:31], s46 offen offset:0 lds
    buffer_load_dwordx4 v14, s[28:31], s46 offen offset:1024 lds
    buffer_load_dwordx4 v15, s[28:31], s46 offen offset:2048 lds
    buffer_load_dwordx4 v16, s[28:31], s46 offen offset:3072 lds
    s_add_u32 s46, s46, 0x20000
    s_cmp_ge_u32 s46, s65
    s_cselect_b32 s3, 0x180000, 0
    s_sub_u32 s46, s46, s3
L_c_done:
    s_waitcnt vmcnt(0)
    s_barrier
    s_add_u32 s36, s8, 0x980000
    s_addc_u32 s37, s9, 0
    s_mov_b32 s38, 0x10000
    s_mov_b32 s39, 0x00020000
    s_lshl_b32 s49, s2, 8
    v_mov_b32 v2, 0
    v_mov_b32 v3, 3
    v_cmp_eq_u32 vcc, 0, v0
    s_and_saveexec_b64 s[62:63], vcc
    s_cbranch_execz L_pub3
    buffer_store_dword v3, v2, s[36:39], s49 offen sc1

L_pub3:
    s_mov_b64 exec, s[62:63]
    s_add_u32 m0, s96, 0x18000
    s_nop 0
    buffer_load_dwordx4 v13, s[28:31], s46 offen offset:0 lds
    buffer_load_dwordx4 v14, s[28:31], s46 offen offset:1024 lds
    buffer_load_dwordx4 v15, s[28:31], s46 offen offset:2048 lds
    buffer_load_dwordx4 v16, s[28:31], s46 offen offset:3072 lds
    s_add_u32 s46, s46, 0x20000
    s_cmp_ge_u32 s46, s65
    s_cselect_b32 s3, 0x180000, 0
    s_sub_u32 s46, s46, s3
    s_add_u32 m0, s96, 0x1c000
    s_nop 0
    buffer_load_dwordx4 v13, s[28:31], s46 offen offset:0 lds
    buffer_load_dwordx4 v14, s[28:31], s46 offen offset:1024 lds
    buffer_load_dwordx4 v15, s[28:31], s46 offen offset:2048 lds
    buffer_load_dwordx4 v16, s[28:31], s46 offen offset:3072 lds
    s_add_u32 s46, s46, 0x20000
    s_cmp_ge_u32 s46, s65
    s_cselect_b32 s3, 0x180000, 0
    s_sub_u32 s46, s46, s3
    s_add_u32 m0, s96, 0x20000
    s_nop 0
    buffer_load_dwordx4 v13, s[28:31], s46 offen offset:0 lds
    buffer_load_dwordx4 v14, s[28:31], s46 offen offset:1024 lds
    buffer_load_dwordx4 v15, s[28:31], s46 offen offset:2048 lds
    buffer_load_dwordx4 v16, s[28:31], s46 offen offset:3072 lds
    s_add_u32 s46, s46, 0x20000
    s_cmp_ge_u32 s46, s65
    s_cselect_b32 s3, 0x180000, 0
    s_sub_u32 s46, s46, s3
    s_add_u32 m0, s96, 0x24000
    s_nop 0
    buffer_load_dwordx4 v13, s[28:31], s46 offen offset:0 lds
    buffer_load_dwordx4 v14, s[28:31], s46 offen offset:1024 lds
    buffer_load_dwordx4 v15, s[28:31], s46 offen offset:2048 lds
    buffer_load_dwordx4 v16, s[28:31], s46 offen offset:3072 lds
    s_add_u32 s46, s46, 0x20000
    s_cmp_ge_u32 s46, s65
    s_cselect_b32 s3, 0x180000, 0
    s_sub_u32 s46, s46, s3
    s_and_b32 s53, s51, 3
    s_and_b32 s54, s50, 1
    s_lshl_b32 s54, s54, 2
    s_add_u32 s53, s53, s54
    s_lshr_b32 s52, s51, 2
    s_lshr_b32 s54, s50, 1
    s_lshl_b32 s54, s54, 3
    s_add_u32 s52, s52, s54
    s_mul_i32 s45, s44, 0x78000
    s_mul_i32 s61, s53, 0x1400
    s_add_u32 s45, s45, s61
    s_lshl_b32 s57, s52, 7
    s_lshl_b32 s58, s52, 1
    s_lshr_b32 s49, s44, 1
    s_add_u32 s58, s58, s49
    s_mul_i32 s58, s58, 0xa000
    s_add_u32 s58, s58, s61
    s_lshl_b32 s59, s44, 5
    s_add_u32 s59, s59, s57

    s_add_u32 s64, s45, 0x78000
    s_mul_i32 s3, s48, 0xa000
    s_add_u32 s45, s45, s3
    v_lshlrev_b32 v8, 4, v1
    v_add_u32 v9, 0x1000, v8
    s_mov_b32 s32, s18
    s_mov_b32 s33, s19
    s_mov_b32 s34, 0x1000
    s_mov_b32 s35, 0x00020000
    s_add_u32 s40, s8, 0x280000
    s_addc_u32 s41, s9, 0
    s_mov_b32 s42, 0x280000
    s_mov_b32 s43, 0x00020000
    v_and_b32 v7, 15, v1
    v_lshlrev_b32 v6, 1, v7
    buffer_load_ushort v144, v6, s[32:35], s59 offen
    s_add_u32 s24, s8, 0x780000
    s_addc_u32 s25, s9, 0
    s_mov_b32 s26, 0x1e0000
    s_mov_b32 s27, 0x00020000
    v_lshrrev_b32 v2, 2, v1
    v_and_b32 v3, 6, v2
    v_bfe_u32 v4, v1, 1, 1
    v_and_b32 v5, 1, v1
    v_lshlrev_b32 v5, 3, v5
    v_lshl_add_u32 v5, v2, 7, v5

    v_add_u32 v5, s96, v5
    s_add_u32 s49, s44, 0
    s_and_b32 s49, s49, 3
    s_lshl_b32 s49, s49, 1
    v_or_b32 v6, s49, v4
    v_xor_b32 v6, v6, v3
    v_lshl_add_u32 v18, v6, 4, v5
    v_add_u32 v240, 0x10000, v18
    v_add_u32 v244, 0x20000, v18
    s_add_u32 s49, s44, 1
    s_and_b32 s49, s49, 3
    s_lshl_b32 s49, s49, 1
    v_or_b32 v6, s49, v4
    v_xor_b32 v6, v6, v3
    v_lshl_add_u32 v19, v6, 4, v5
    v_add_u32 v241, 0x10000, v19
    v_add_u32 v245, 0x20000, v19
    s_add_u32 s49, s44, 2
    s_and_b32 s49, s49, 3
    s_lshl_b32 s49, s49, 1
    v_or_b32 v6, s49, v4
    v_xor_b32 v6, v6, v3
    v_lshl_add_u32 v20, v6, 4, v5
    v_add_u32 v242, 0x10000, v20
    v_add_u32 v246, 0x20000, v20
    s_add_u32 s49, s44, 3
    s_and_b32 s49, s49, 3
    s_lshl_b32 s49, s49, 1
    v_or_b32 v6, s49, v4
    v_xor_b32 v6, v6, v3
    v_lshl_add_u32 v21, v6, 4, v5
    v_add_u32 v243, 0x10000, v21
    v_add_u32 v247, 0x20000, v21
    v_lshrrev_b32 v6, 4, v1
    v_and_b32 v4, 1, v7
    v_lshlrev_b32 v4, 4, v4
    v_mov_b32 v5, 0x3f80
    v_lshlrev_b32 v5, v4, v5
    v_lshrrev_b32 v3, 3, v7
    v_sub_u32 v3, v6, v3
    v_bfe_u32 v4, v7, 1, 2
    v_lshl_add_u32 v3, v3, 1, v4
    v_and_b32 v2, 1, v6
    v_lshrrev_b32 v4, 3, v7
    v_cmp_eq_u32 vcc, v2, v4
    s_nop 1
    v_cndmask_b32 v5, 0, v5, vcc

    v_cmp_eq_u32 vcc, 0, v3
    s_nop 1
    v_cndmask_b32 v136, 0, v5, vcc
    v_cmp_eq_u32 vcc, 1, v3
    s_nop 1
    v_cndmask_b32 v137, 0, v5, vcc
    v_cmp_eq_u32 vcc, 2, v3
    s_nop 1
    v_cndmask_b32 v138, 0, v5, vcc
    v_cmp_eq_u32 vcc, 3, v3
    s_nop 1
    v_cndmask_b32 v139, 0, v5, vcc
    v_cmp_eq_u32 vcc, 4, v3
    s_nop 1
    v_cndmask_b32 v140, 0, v5, vcc
    v_cmp_eq_u32 vcc, 5, v3
    s_nop 1
    v_cndmask_b32 v141, 0, v5, vcc
    v_cmp_eq_u32 vcc, 6, v3
    s_nop 1
    v_cndmask_b32 v142, 0, v5, vcc
    v_cmp_eq_u32 vcc, 7, v3
    s_nop 1
    v_cndmask_b32 v143, 0, v5, vcc
    s_and_b32 s49, s44, 1
    s_cmp_eq_u32 s49, 1
    s_cselect_b64 s[62:63], -1, 0
    v_cndmask_b32 v136, v136, v140, s[62:63]
    v_cndmask_b32 v137, v137, v141, s[62:63]
    v_cndmask_b32 v138, v138, v142, s[62:63]
    v_cndmask_b32 v139, v139, v143, s[62:63]
    v_mov_b32 v56, 0
    v_mov_b32 v57, 0
    v_mov_b32 v58, 0
    v_mov_b32 v59, 0
    v_mov_b32 v60, 0
    v_mov_b32 v61, 0
    v_mov_b32 v62, 0
    v_mov_b32 v63, 0
    v_mov_b32 v64, 0
    v_mov_b32 v65, 0
    v_mov_b32 v66, 0
    v_mov_b32 v67, 0
    v_mov_b32 v68, 0
    v_mov_b32 v69, 0
    v_mov_b32 v70, 0
    v_mov_b32 v71, 0
    v_mov_b32 v72, 0
    v_mov_b32 v73, 0
    v_mov_b32 v74, 0
    v_mov_b32 v75, 0
    v_mov_b32 v76, 0
    v_mov_b32 v77, 0
    v_mov_b32 v78, 0
    v_mov_b32 v79, 0
    v_mov_b32 v80, 0
    v_mov_b32 v81, 0
    v_mov_b32 v82, 0
    v_mov_b32 v83, 0
    v_mov_b32 v84, 0
    v_mov_b32 v85, 0
    v_mov_b32 v86, 0
    v_mov_b32 v87, 0
    v_mov_b32 v88, 0
    v_mov_b32 v89, 0
    v_mov_b32 v90, 0
    v_mov_b32 v91, 0
    v_mov_b32 v92, 0
    v_mov_b32 v93, 0
    v_mov_b32 v94, 0
    v_mov_b32 v95, 0
    v_mov_b32 v96, 0
    v_mov_b32 v97, 0
    v_mov_b32 v98, 0
    v_mov_b32 v99, 0
    v_mov_b32 v100, 0
    v_mov_b32 v101, 0
    v_mov_b32 v102, 0
    v_mov_b32 v103, 0
    v_mov_b32 v104, 0
    v_mov_b32 v105, 0
    v_mov_b32 v106, 0
    v_mov_b32 v107, 0
    v_mov_b32 v108, 0
    v_mov_b32 v109, 0
    v_mov_b32 v110, 0
    v_mov_b32 v111, 0
    v_mov_b32 v112, 0
    v_mov_b32 v113, 0
    v_mov_b32 v114, 0
    v_mov_b32 v115, 0
    v_mov_b32 v116, 0
    v_mov_b32 v117, 0
    v_mov_b32 v118, 0
    v_mov_b32 v119, 0
    v_mov_b32 v120, 0
    v_mov_b32 v121, 0
    v_mov_b32 v122, 0
    v_mov_b32 v123, 0
    v_mov_b32 v124, 0
    v_mov_b32 v125, 0
    v_mov_b32 v126, 0
    v_mov_b32 v127, 0
    v_mov_b32 v128, 0
    v_mov_b32 v129, 0
    v_mov_b32 v130, 0
    v_mov_b32 v131, 0
    v_mov_b32 v132, 0
    v_mov_b32 v133, 0
    v_mov_b32 v134, 0
    v_mov_b32 v135, 0
    s_mul_i32 s49, s53, 80
    s_lshr_b32 s62, s49, 6
    s_add_u32 s49, s49, 79
    s_lshr_b32 s63, s49, 6
    v_mov_b32 v3, s62
    v_mov_b32 v4, s63
    v_and_b32 v2, 8, v1
    v_cmp_eq_u32 vcc, 0, v2
    v_and_b32 v5, 7, v1
    v_min_u32 v5, 5, v5
    v_cndmask_b32 v3, v4, v3, vcc
    v_cmp_le_u32 vcc, 5, v3
    v_mul_u32_u24 v5, 5, v5
    v_add_u32 v5, v5, v3
    v_subrev_u32 v4, 5, v5
    v_cndmask_b32 v5, v5, v4, vcc
    v_cndmask_b32 v4, 0, 1, vcc
    s_lshl_b32 s49, s44, 1
    v_add_u32 v4, s49, v4
    v_lshl_add_u32 v2, v5, 3, v4
    v_lshlrev_b32 v2, 8, v2
    v_mov_b32 v3, 3
    s_and_b32 s49, s52, 3
    s_lshl_b32 s49, s49, 3
    s_add_u32 s49, s49, s53
    s_lshl_b32 s49, s49, 3
    s_lshr_b32 s62, s52, 2
    s_add_u32 s49, s49, s62
    s_lshl_b32 s49, s49, 8
    v_mov_b32 v4, s49
    v_cmp_eq_u32 vcc, 16, v1
    s_nop 1
    v_cndmask_b32 v2, v2, v4, vcc
    v_cndmask_b32 v3, v3, 2, vcc

    s_mov_b32 s67, 0
L_poll_s4:
    buffer_load_dword v255, v2, s[36:39], 0 offen sc1
    s_add_u32 s67, s67, 1
    s_waitcnt vmcnt(0)
    v_cmp_le_u32 vcc, v3, v255
    s_cmp_eq_u64 vcc, -1
    s_cbranch_scc1 L_go_s4
    s_sleep 8
    s_cmp_lt_u32 s67, 262144
    s_cbranch_scc1 L_poll_s4

L_go_s4:
    buffer_load_dwordx4 a[128:131], v8, s[40:43], s58 offen offset:0 sc1
    buffer_load_dwordx4 a[132:135], v8, s[40:43], s58 offen offset:1024 sc1
    buffer_load_dwordx4 a[136:139], v8, s[40:43], s58 offen offset:2048 sc1
    buffer_load_dwordx4 a[140:143], v8, s[40:43], s58 offen offset:3072 sc1
    buffer_load_dwordx4 a[144:147], v9, s[40:43], s58 offen offset:0 sc1
    buffer_load_dwordx4 a[0:3], v8, s[24:27], s45 offen offset:0 sc1
    buffer_load_dwordx4 a[4:7], v8, s[24:27], s45 offen offset:1024 sc1
    buffer_load_dwordx4 a[8:11], v8, s[24:27], s45 offen offset:2048 sc1
    buffer_load_dwordx4 a[12:15], v8, s[24:27], s45 offen offset:3072 sc1
    buffer_load_dwordx4 a[16:19], v9, s[24:27], s45 offen sc1
    s_add_u32 s45, s45, 0xa000
    s_cmp_ge_u32 s45, s64
    s_cselect_b32 s3, 0x78000, 0
    s_sub_u32 s45, s45, s3
    buffer_load_dwordx4 a[20:23], v8, s[24:27], s45 offen offset:0 sc1
    buffer_load_dwordx4 a[24:27], v8, s[24:27], s45 offen offset:1024 sc1
    buffer_load_dwordx4 a[28:31], v8, s[24:27], s45 offen offset:2048 sc1
    buffer_load_dwordx4 a[32:35], v8, s[24:27], s45 offen offset:3072 sc1
    buffer_load_dwordx4 a[36:39], v9, s[24:27], s45 offen sc1
    s_add_u32 s45, s45, 0xa000
    s_cmp_ge_u32 s45, s64
    s_cselect_b32 s3, 0x78000, 0
    s_sub_u32 s45, s45, s3
    buffer_load_dwordx4 a[40:43], v8, s[24:27], s45 offen offset:0 sc1
    buffer_load_dwordx4 a[44:47], v8, s[24:27], s45 offen offset:1024 sc1
    buffer_load_dwordx4 a[48:51], v8, s[24:27], s45 offen offset:2048 sc1
    buffer_load_dwordx4 a[52:55], v8, s[24:27], s45 offen offset:3072 sc1
    buffer_load_dwordx4 a[56:59], v9, s[24:27], s45 offen sc1
    s_add_u32 s45, s45, 0xa000
    s_cmp_ge_u32 s45, s64
    s_cselect_b32 s3, 0x78000, 0
    s_sub_u32 s45, s45, s3
    buffer_load_dwordx4 a[60:63], v8, s[24:27], s45 offen offset:0 sc1
    buffer_load_dwordx4 a[64:67], v8, s[24:27], s45 offen offset:1024 sc1
    buffer_load_dwordx4 a[68:71], v8, s[24:27], s45 offen offset:2048 sc1
    buffer_load_dwordx4 a[72:75], v8, s[24:27], s45 offen offset:3072 sc1
    buffer_load_dwordx4 a[76:79], v9, s[24:27], s45 offen sc1
    s_add_u32 s45, s45, 0xa000
    s_cmp_ge_u32 s45, s64
    s_cselect_b32 s3, 0x78000, 0
    s_sub_u32 s45, s45, s3
    s_waitcnt vmcnt(15)
    ds_read_b64_tr_b16 v[24:25], v18 offset:0
    ds_read_b64_tr_b16 v[26:27], v18 offset:2048
    ds_read_b64_tr_b16 v[28:29], v19 offset:0
    ds_read_b64_tr_b16 v[30:31], v19 offset:2048
    ds_read_b64_tr_b16 v[32:33], v20 offset:0
    ds_read_b64_tr_b16 v[34:35], v20 offset:2048
    ds_read_b64_tr_b16 v[36:37], v21 offset:0
    ds_read_b64_tr_b16 v[38:39], v21 offset:2048
    v_mfma_f32_16x16x32_bf16 v[56:59], a[128:131], v[136:139], v[56:59]
    v_mfma_f32_16x16x32_bf16 v[60:63], a[132:135], v[136:139], v[60:63]
    v_mfma_f32_16x16x32_bf16 v[64:67], a[136:139], v[136:139], v[64:67]
    v_mfma_f32_16x16x32_bf16 v[68:71], a[140:143], v[136:139], v[68:71]
    v_mfma_f32_16x16x32_bf16 v[72:75], a[144:147], v[136:139], v[72:75]
    s_waitcnt lgkmcnt(0)
    v_mfma_f32_16x16x32_bf16 v[56:59], a[0:3], v[24:27], v[56:59]
    s_add_u32 m0, s96, 0x0
    s_nop 0
    buffer_load_dwordx4 v13, s[28:31], s46 offen offset:0 lds
    v_mfma_f32_16x16x32_bf16 v[60:63], a[4:7], v[24:27], v[60:63]
    v_mfma_f32_16x16x32_bf16 v[64:67], a[8:11], v[24:27], v[64:67]
    buffer_load_dwordx4 a[80:83], v8, s[24:27], s45 offen offset:0 sc1
    v_mfma_f32_16x16x32_bf16 v[68:71], a[12:15], v[24:27], v[68:71]
    v_mfma_f32_16x16x32_bf16 v[72:75], a[16:19], v[24:27], v[72:75]
    buffer_load_dwordx4 v14, s[28:31], s46 offen offset:1024 lds
    v_mfma_f32_16x16x32_bf16 v[76:79], a[0:3], v[28:31], v[76:79]
    v_mfma_f32_16x16x32_bf16 v[80:83], a[4:7], v[28:31], v[80:83]
    buffer_load_dwordx4 a[84:87], v8, s[24:27], s45 offen offset:1024 sc1
    v_mfma_f32_16x16x32_bf16 v[84:87], a[8:11], v[28:31], v[84:87]
    v_mfma_f32_16x16x32_bf16 v[88:91], a[12:15], v[28:31], v[88:91]
    buffer_load_dwordx4 v15, s[28:31], s46 offen offset:2048 lds
    v_mfma_f32_16x16x32_bf16 v[92:95], a[16:19], v[28:31], v[92:95]
    s_waitcnt vmcnt(15)
    ds_read_b64_tr_b16 v[40:41], v18 offset:16384
    v_mfma_f32_16x16x32_bf16 v[96:99], a[0:3], v[32:35], v[96:99]
    ds_read_b64_tr_b16 v[42:43], v18 offset:18432
    v_mfma_f32_16x16x32_bf16 v[100:103], a[4:7], v[32:35], v[100:103]
    buffer_load_dwordx4 a[88:91], v8, s[24:27], s45 offen offset:2048 sc1
    ds_read_b64_tr_b16 v[44:45], v19 offset:16384
    v_mfma_f32_16x16x32_bf16 v[104:107], a[8:11], v[32:35], v[104:107]
    ds_read_b64_tr_b16 v[46:47], v19 offset:18432
    v_mfma_f32_16x16x32_bf16 v[108:111], a[12:15], v[32:35], v[108:111]
    buffer_load_dwordx4 v16, s[28:31], s46 offen offset:3072 lds
    s_add_u32 s46, s46, 0x20000
    s_cmp_ge_u32 s46, s65
    s_cselect_b32 s3, 0x180000, 0
    s_sub_u32 s46, s46, s3
    ds_read_b64_tr_b16 v[48:49], v20 offset:16384
    v_mfma_f32_16x16x32_bf16 v[112:115], a[16:19], v[32:35], v[112:115]
    ds_read_b64_tr_b16 v[50:51], v20 offset:18432
    v_mfma_f32_16x16x32_bf16 v[116:119], a[0:3], v[36:39], v[116:119]
    buffer_load_dwordx4 a[92:95], v8, s[24:27], s45 offen offset:3072 sc1
    ds_read_b64_tr_b16 v[52:53], v21 offset:16384
    v_mfma_f32_16x16x32_bf16 v[120:123], a[4:7], v[36:39], v[120:123]
    ds_read_b64_tr_b16 v[54:55], v21 offset:18432
    v_mfma_f32_16x16x32_bf16 v[124:127], a[8:11], v[36:39], v[124:127]
    buffer_load_dwordx4 a[96:99], v9, s[24:27], s45 offen sc1
    s_add_u32 s45, s45, 0xa000
    s_cmp_ge_u32 s45, s64
    s_cselect_b32 s3, 0x78000, 0
    s_sub_u32 s45, s45, s3
    v_mfma_f32_16x16x32_bf16 v[128:131], a[12:15], v[36:39], v[128:131]
    v_mfma_f32_16x16x32_bf16 v[132:135], a[16:19], v[36:39], v[132:135]
    s_waitcnt lgkmcnt(0)
    v_mfma_f32_16x16x32_bf16 v[56:59], a[20:23], v[40:43], v[56:59]
    s_add_u32 m0, s96, 0x4000
    s_nop 0
    buffer_load_dwordx4 v13, s[28:31], s46 offen offset:0 lds
    v_mfma_f32_16x16x32_bf16 v[60:63], a[24:27], v[40:43], v[60:63]
    v_mfma_f32_16x16x32_bf16 v[64:67], a[28:31], v[40:43], v[64:67]
    buffer_load_dwordx4 a[0:3], v8, s[24:27], s45 offen offset:0 sc1
    v_mfma_f32_16x16x32_bf16 v[68:71], a[32:35], v[40:43], v[68:71]
    v_mfma_f32_16x16x32_bf16 v[72:75], a[36:39], v[40:43], v[72:75]
    buffer_load_dwordx4 v14, s[28:31], s46 offen offset:1024 lds
    v_mfma_f32_16x16x32_bf16 v[76:79], a[20:23], v[44:47], v[76:79]
    v_mfma_f32_16x16x32_bf16 v[80:83], a[24:27], v[44:47], v[80:83]
    buffer_load_dwordx4 a[4:7], v8, s[24:27], s45 offen offset:1024 sc1
    v_mfma_f32_16x16x32_bf16 v[84:87], a[28:31], v[44:47], v[84:87]
    v_mfma_f32_16x16x32_bf16 v[88:91], a[32:35], v[44:47], v[88:91]
    buffer_load_dwordx4 v15, s[28:31], s46 offen offset:2048 lds
    v_mfma_f32_16x16x32_bf16 v[92:95], a[36:39], v[44:47], v[92:95]
    s_waitcnt vmcnt(19)
    ds_read_b64_tr_b16 v[24:25], v18 offset:32768
    v_mfma_f32_16x16x32_bf16 v[96:99], a[20:23], v[48:51], v[96:99]
    ds_read_b64_tr_b16 v[26:27], v18 offset:34816
    v_mfma_f32_16x16x32_bf16 v[100:103], a[24:27], v[48:51], v[100:103]
    buffer_load_dwordx4 a[8:11], v8, s[24:27], s45 offen offset:2048 sc1
    ds_read_b64_tr_b16 v[28:29], v19 offset:32768
    v_mfma_f32_16x16x32_bf16 v[104:107], a[28:31], v[48:51], v[104:107]
    ds_read_b64_tr_b16 v[30:31], v19 offset:34816
    v_mfma_f32_16x16x32_bf16 v[108:111], a[32:35], v[48:51], v[108:111]
    buffer_load_dwordx4 v16, s[28:31], s46 offen offset:3072 lds
    s_add_u32 s46, s46, 0x20000
    s_cmp_ge_u32 s46, s65
    s_cselect_b32 s3, 0x180000, 0
    s_sub_u32 s46, s46, s3
    ds_read_b64_tr_b16 v[32:33], v20 offset:32768
    v_mfma_f32_16x16x32_bf16 v[112:115], a[36:39], v[48:51], v[112:115]
    ds_read_b64_tr_b16 v[34:35], v20 offset:34816
    v_mfma_f32_16x16x32_bf16 v[116:119], a[20:23], v[52:55], v[116:119]
    buffer_load_dwordx4 a[12:15], v8, s[24:27], s45 offen offset:3072 sc1
    ds_read_b64_tr_b16 v[36:37], v21 offset:32768
    v_mfma_f32_16x16x32_bf16 v[120:123], a[24:27], v[52:55], v[120:123]
    ds_read_b64_tr_b16 v[38:39], v21 offset:34816
    v_mfma_f32_16x16x32_bf16 v[124:127], a[28:31], v[52:55], v[124:127]
    buffer_load_dwordx4 a[16:19], v9, s[24:27], s45 offen sc1
    s_add_u32 s45, s45, 0xa000
    s_cmp_ge_u32 s45, s64
    s_cselect_b32 s3, 0x78000, 0
    s_sub_u32 s45, s45, s3
    v_mfma_f32_16x16x32_bf16 v[128:131], a[32:35], v[52:55], v[128:131]
    v_mfma_f32_16x16x32_bf16 v[132:135], a[36:39], v[52:55], v[132:135]
    s_waitcnt lgkmcnt(0)
    v_mfma_f32_16x16x32_bf16 v[56:59], a[40:43], v[24:27], v[56:59]
    buffer_load_dwordx4 a[20:23], v8, s[24:27], s45 offen offset:0 sc1
    v_mfma_f32_16x16x32_bf16 v[60:63], a[44:47], v[24:27], v[60:63]
    v_mfma_f32_16x16x32_bf16 v[64:67], a[48:51], v[24:27], v[64:67]
    v_mfma_f32_16x16x32_bf16 v[68:71], a[52:55], v[24:27], v[68:71]
    v_mfma_f32_16x16x32_bf16 v[72:75], a[56:59], v[24:27], v[72:75]
    buffer_load_dwordx4 a[24:27], v8, s[24:27], s45 offen offset:1024 sc1
    v_mfma_f32_16x16x32_bf16 v[76:79], a[40:43], v[28:31], v[76:79]
    v_mfma_f32_16x16x32_bf16 v[80:83], a[44:47], v[28:31], v[80:83]
    v_mfma_f32_16x16x32_bf16 v[84:87], a[48:51], v[28:31], v[84:87]
    v_mfma_f32_16x16x32_bf16 v[88:91], a[52:55], v[28:31], v[88:91]
    buffer_load_dwordx4 a[28:31], v8, s[24:27], s45 offen offset:2048 sc1
    v_mfma_f32_16x16x32_bf16 v[92:95], a[56:59], v[28:31], v[92:95]
    s_waitcnt vmcnt(21)
    ds_read_b64_tr_b16 v[40:41], v18 offset:49152
    v_mfma_f32_16x16x32_bf16 v[96:99], a[40:43], v[32:35], v[96:99]
    ds_read_b64_tr_b16 v[42:43], v18 offset:51200
    v_mfma_f32_16x16x32_bf16 v[100:103], a[44:47], v[32:35], v[100:103]
    ds_read_b64_tr_b16 v[44:45], v19 offset:49152
    v_mfma_f32_16x16x32_bf16 v[104:107], a[48:51], v[32:35], v[104:107]
    buffer_load_dwordx4 a[32:35], v8, s[24:27], s45 offen offset:3072 sc1
    ds_read_b64_tr_b16 v[46:47], v19 offset:51200
    v_mfma_f32_16x16x32_bf16 v[108:111], a[52:55], v[32:35], v[108:111]
    ds_read_b64_tr_b16 v[48:49], v20 offset:49152
    v_mfma_f32_16x16x32_bf16 v[112:115], a[56:59], v[32:35], v[112:115]
    ds_read_b64_tr_b16 v[50:51], v20 offset:51200
    v_mfma_f32_16x16x32_bf16 v[116:119], a[40:43], v[36:39], v[116:119]
    ds_read_b64_tr_b16 v[52:53], v21 offset:49152
    v_mfma_f32_16x16x32_bf16 v[120:123], a[44:47], v[36:39], v[120:123]
    buffer_load_dwordx4 a[36:39], v9, s[24:27], s45 offen sc1
    s_add_u32 s45, s45, 0xa000
    s_cmp_ge_u32 s45, s64
    s_cselect_b32 s3, 0x78000, 0
    s_sub_u32 s45, s45, s3
    ds_read_b64_tr_b16 v[54:55], v21 offset:51200
    v_mfma_f32_16x16x32_bf16 v[124:127], a[48:51], v[36:39], v[124:127]
    v_mfma_f32_16x16x32_bf16 v[128:131], a[52:55], v[36:39], v[128:131]
    v_mfma_f32_16x16x32_bf16 v[132:135], a[56:59], v[36:39], v[132:135]
    s_waitcnt lgkmcnt(0)
    v_mfma_f32_16x16x32_bf16 v[56:59], a[60:63], v[40:43], v[56:59]
    buffer_load_dwordx4 a[40:43], v8, s[24:27], s45 offen offset:0 sc1
    v_mfma_f32_16x16x32_bf16 v[60:63], a[64:67], v[40:43], v[60:63]
    v_mfma_f32_16x16x32_bf16 v[64:67], a[68:71], v[40:43], v[64:67]
    v_mfma_f32_16x16x32_bf16 v[68:71], a[72:75], v[40:43], v[68:71]
    v_mfma_f32_16x16x32_bf16 v[72:75], a[76:79], v[40:43], v[72:75]
    buffer_load_dwordx4 a[44:47], v8, s[24:27], s45 offen offset:1024 sc1
    v_mfma_f32_16x16x32_bf16 v[76:79], a[60:63], v[44:47], v[76:79]
    v_mfma_f32_16x16x32_bf16 v[80:83], a[64:67], v[44:47], v[80:83]
    v_mfma_f32_16x16x32_bf16 v[84:87], a[68:71], v[44:47], v[84:87]
    v_mfma_f32_16x16x32_bf16 v[88:91], a[72:75], v[44:47], v[88:91]
    buffer_load_dwordx4 a[48:51], v8, s[24:27], s45 offen offset:2048 sc1
    v_mfma_f32_16x16x32_bf16 v[92:95], a[76:79], v[44:47], v[92:95]
    s_waitcnt vmcnt(17)
    ds_read_b64_tr_b16 v[24:25], v240 offset:0
    v_mfma_f32_16x16x32_bf16 v[96:99], a[60:63], v[48:51], v[96:99]
    ds_read_b64_tr_b16 v[26:27], v240 offset:2048
    v_mfma_f32_16x16x32_bf16 v[100:103], a[64:67], v[48:51], v[100:103]
    ds_read_b64_tr_b16 v[28:29], v241 offset:0
    v_mfma_f32_16x16x32_bf16 v[104:107], a[68:71], v[48:51], v[104:107]
    buffer_load_dwordx4 a[52:55], v8, s[24:27], s45 offen offset:3072 sc1
    ds_read_b64_tr_b16 v[30:31], v241 offset:2048
    v_mfma_f32_16x16x32_bf16 v[108:111], a[72:75], v[48:51], v[108:111]
    ds_read_b64_tr_b16 v[32:33], v242 offset:0
    v_mfma_f32_16x16x32_bf16 v[112:115], a[76:79], v[48:51], v[112:115]
    ds_read_b64_tr_b16 v[34:35], v242 offset:2048
    v_mfma_f32_16x16x32_bf16 v[116:119], a[60:63], v[52:55], v[116:119]
    ds_read_b64_tr_b16 v[36:37], v243 offset:0
    v_mfma_f32_16x16x32_bf16 v[120:123], a[64:67], v[52:55], v[120:123]
    buffer_load_dwordx4 a[56:59], v9, s[24:27], s45 offen sc1
    s_add_u32 s45, s45, 0xa000
    s_cmp_ge_u32 s45, s64
    s_cselect_b32 s3, 0x78000, 0
    s_sub_u32 s45, s45, s3
    ds_read_b64_tr_b16 v[38:39], v243 offset:2048
    v_mfma_f32_16x16x32_bf16 v[124:127], a[68:71], v[52:55], v[124:127]
    v_mfma_f32_16x16x32_bf16 v[128:131], a[72:75], v[52:55], v[128:131]
    v_mfma_f32_16x16x32_bf16 v[132:135], a[76:79], v[52:55], v[132:135]
    s_waitcnt lgkmcnt(0)
    v_mfma_f32_16x16x32_bf16 v[56:59], a[80:83], v[24:27], v[56:59]
    buffer_load_dwordx4 a[60:63], v8, s[24:27], s45 offen offset:0 sc1
    v_mfma_f32_16x16x32_bf16 v[60:63], a[84:87], v[24:27], v[60:63]
    v_mfma_f32_16x16x32_bf16 v[64:67], a[88:91], v[24:27], v[64:67]
    v_mfma_f32_16x16x32_bf16 v[68:71], a[92:95], v[24:27], v[68:71]
    v_mfma_f32_16x16x32_bf16 v[72:75], a[96:99], v[24:27], v[72:75]
    buffer_load_dwordx4 a[64:67], v8, s[24:27], s45 offen offset:1024 sc1
    v_mfma_f32_16x16x32_bf16 v[76:79], a[80:83], v[28:31], v[76:79]
    v_mfma_f32_16x16x32_bf16 v[80:83], a[84:87], v[28:31], v[80:83]
    v_mfma_f32_16x16x32_bf16 v[84:87], a[88:91], v[28:31], v[84:87]
    v_mfma_f32_16x16x32_bf16 v[88:91], a[92:95], v[28:31], v[88:91]
    buffer_load_dwordx4 a[68:71], v8, s[24:27], s45 offen offset:2048 sc1
    v_mfma_f32_16x16x32_bf16 v[92:95], a[96:99], v[28:31], v[92:95]
    s_waitcnt vmcnt(13)
    ds_read_b64_tr_b16 v[40:41], v240 offset:16384
    v_mfma_f32_16x16x32_bf16 v[96:99], a[80:83], v[32:35], v[96:99]
    ds_read_b64_tr_b16 v[42:43], v240 offset:18432
    v_mfma_f32_16x16x32_bf16 v[100:103], a[84:87], v[32:35], v[100:103]
    ds_read_b64_tr_b16 v[44:45], v241 offset:16384
    v_mfma_f32_16x16x32_bf16 v[104:107], a[88:91], v[32:35], v[104:107]
    buffer_load_dwordx4 a[72:75], v8, s[24:27], s45 offen offset:3072 sc1
    ds_read_b64_tr_b16 v[46:47], v241 offset:18432
    v_mfma_f32_16x16x32_bf16 v[108:111], a[92:95], v[32:35], v[108:111]
    ds_read_b64_tr_b16 v[48:49], v242 offset:16384
    v_mfma_f32_16x16x32_bf16 v[112:115], a[96:99], v[32:35], v[112:115]
    ds_read_b64_tr_b16 v[50:51], v242 offset:18432
    v_mfma_f32_16x16x32_bf16 v[116:119], a[80:83], v[36:39], v[116:119]
    ds_read_b64_tr_b16 v[52:53], v243 offset:16384
    v_mfma_f32_16x16x32_bf16 v[120:123], a[84:87], v[36:39], v[120:123]
    buffer_load_dwordx4 a[76:79], v9, s[24:27], s45 offen sc1
    s_add_u32 s45, s45, 0xa000
    s_cmp_ge_u32 s45, s64
    s_cselect_b32 s3, 0x78000, 0
    s_sub_u32 s45, s45, s3
    ds_read_b64_tr_b16 v[54:55], v243 offset:18432
    v_mfma_f32_16x16x32_bf16 v[124:127], a[88:91], v[36:39], v[124:127]
    v_mfma_f32_16x16x32_bf16 v[128:131], a[92:95], v[36:39], v[128:131]
    v_mfma_f32_16x16x32_bf16 v[132:135], a[96:99], v[36:39], v[132:135]
    s_waitcnt lgkmcnt(0)
    v_mfma_f32_16x16x32_bf16 v[56:59], a[0:3], v[40:43], v[56:59]
    buffer_load_dwordx4 a[80:83], v8, s[24:27], s45 offen offset:0 sc1
    v_mfma_f32_16x16x32_bf16 v[60:63], a[4:7], v[40:43], v[60:63]
    v_mfma_f32_16x16x32_bf16 v[64:67], a[8:11], v[40:43], v[64:67]
    v_mfma_f32_16x16x32_bf16 v[68:71], a[12:15], v[40:43], v[68:71]
    v_mfma_f32_16x16x32_bf16 v[72:75], a[16:19], v[40:43], v[72:75]
    buffer_load_dwordx4 a[84:87], v8, s[24:27], s45 offen offset:1024 sc1
    v_mfma_f32_16x16x32_bf16 v[76:79], a[0:3], v[44:47], v[76:79]
    v_mfma_f32_16x16x32_bf16 v[80:83], a[4:7], v[44:47], v[80:83]
    v_mfma_f32_16x16x32_bf16 v[84:87], a[8:11], v[44:47], v[84:87]
    v_mfma_f32_16x16x32_bf16 v[88:91], a[12:15], v[44:47], v[88:91]
    buffer_load_dwordx4 a[88:91], v8, s[24:27], s45 offen offset:2048 sc1
    v_mfma_f32_16x16x32_bf16 v[92:95], a[16:19], v[44:47], v[92:95]
    s_waitcnt vmcnt(13)
    ds_read_b64_tr_b16 v[24:25], v240 offset:32768
    v_mfma_f32_16x16x32_bf16 v[96:99], a[0:3], v[48:51], v[96:99]
    ds_read_b64_tr_b16 v[26:27], v240 offset:34816
    v_mfma_f32_16x16x32_bf16 v[100:103], a[4:7], v[48:51], v[100:103]
    ds_read_b64_tr_b16 v[28:29], v241 offset:32768
    v_mfma_f32_16x16x32_bf16 v[104:107], a[8:11], v[48:51], v[104:107]
    buffer_load_dwordx4 a[92:95], v8, s[24:27], s45 offen offset:3072 sc1
    ds_read_b64_tr_b16 v[30:31], v241 offset:34816
    v_mfma_f32_16x16x32_bf16 v[108:111], a[12:15], v[48:51], v[108:111]
    ds_read_b64_tr_b16 v[32:33], v242 offset:32768
    v_mfma_f32_16x16x32_bf16 v[112:115], a[16:19], v[48:51], v[112:115]
    ds_read_b64_tr_b16 v[34:35], v242 offset:34816
    v_mfma_f32_16x16x32_bf16 v[116:119], a[0:3], v[52:55], v[116:119]
    ds_read_b64_tr_b16 v[36:37], v243 offset:32768
    v_mfma_f32_16x16x32_bf16 v[120:123], a[4:7], v[52:55], v[120:123]
    buffer_load_dwordx4 a[96:99], v9, s[24:27], s45 offen sc1
    s_add_u32 s45, s45, 0xa000
    s_cmp_ge_u32 s45, s64
    s_cselect_b32 s3, 0x78000, 0
    s_sub_u32 s45, s45, s3
    ds_read_b64_tr_b16 v[38:39], v243 offset:34816
    v_mfma_f32_16x16x32_bf16 v[124:127], a[8:11], v[52:55], v[124:127]
    v_mfma_f32_16x16x32_bf16 v[128:131], a[12:15], v[52:55], v[128:131]
    v_mfma_f32_16x16x32_bf16 v[132:135], a[16:19], v[52:55], v[132:135]
    s_waitcnt lgkmcnt(0)
    v_mfma_f32_16x16x32_bf16 v[56:59], a[20:23], v[24:27], v[56:59]
    buffer_load_dwordx4 a[0:3], v8, s[24:27], s45 offen offset:0 sc1
    v_mfma_f32_16x16x32_bf16 v[60:63], a[24:27], v[24:27], v[60:63]
    v_mfma_f32_16x16x32_bf16 v[64:67], a[28:31], v[24:27], v[64:67]
    v_mfma_f32_16x16x32_bf16 v[68:71], a[32:35], v[24:27], v[68:71]
    v_mfma_f32_16x16x32_bf16 v[72:75], a[36:39], v[24:27], v[72:75]
    buffer_load_dwordx4 a[4:7], v8, s[24:27], s45 offen offset:1024 sc1
    v_mfma_f32_16x16x32_bf16 v[76:79], a[20:23], v[28:31], v[76:79]
    v_mfma_f32_16x16x32_bf16 v[80:83], a[24:27], v[28:31], v[80:83]
    v_mfma_f32_16x16x32_bf16 v[84:87], a[28:31], v[28:31], v[84:87]
    v_mfma_f32_16x16x32_bf16 v[88:91], a[32:35], v[28:31], v[88:91]
    buffer_load_dwordx4 a[8:11], v8, s[24:27], s45 offen offset:2048 sc1
    v_mfma_f32_16x16x32_bf16 v[92:95], a[36:39], v[28:31], v[92:95]
    s_waitcnt vmcnt(13)
    ds_read_b64_tr_b16 v[40:41], v240 offset:49152
    v_mfma_f32_16x16x32_bf16 v[96:99], a[20:23], v[32:35], v[96:99]
    ds_read_b64_tr_b16 v[42:43], v240 offset:51200
    v_mfma_f32_16x16x32_bf16 v[100:103], a[24:27], v[32:35], v[100:103]
    ds_read_b64_tr_b16 v[44:45], v241 offset:49152
    v_mfma_f32_16x16x32_bf16 v[104:107], a[28:31], v[32:35], v[104:107]
    buffer_load_dwordx4 a[12:15], v8, s[24:27], s45 offen offset:3072 sc1
    ds_read_b64_tr_b16 v[46:47], v241 offset:51200
    v_mfma_f32_16x16x32_bf16 v[108:111], a[32:35], v[32:35], v[108:111]
    ds_read_b64_tr_b16 v[48:49], v242 offset:49152
    v_mfma_f32_16x16x32_bf16 v[112:115], a[36:39], v[32:35], v[112:115]
    ds_read_b64_tr_b16 v[50:51], v242 offset:51200
    v_mfma_f32_16x16x32_bf16 v[116:119], a[20:23], v[36:39], v[116:119]
    ds_read_b64_tr_b16 v[52:53], v243 offset:49152
    v_mfma_f32_16x16x32_bf16 v[120:123], a[24:27], v[36:39], v[120:123]
    buffer_load_dwordx4 a[16:19], v9, s[24:27], s45 offen sc1
    s_add_u32 s45, s45, 0xa000
    s_cmp_ge_u32 s45, s64
    s_cselect_b32 s3, 0x78000, 0
    s_sub_u32 s45, s45, s3
    ds_read_b64_tr_b16 v[54:55], v243 offset:51200
    v_mfma_f32_16x16x32_bf16 v[124:127], a[28:31], v[36:39], v[124:127]
    v_mfma_f32_16x16x32_bf16 v[128:131], a[32:35], v[36:39], v[128:131]
    v_mfma_f32_16x16x32_bf16 v[132:135], a[36:39], v[36:39], v[132:135]
    s_waitcnt lgkmcnt(0)
    v_mfma_f32_16x16x32_bf16 v[56:59], a[40:43], v[40:43], v[56:59]
    buffer_load_dwordx4 a[20:23], v8, s[24:27], s45 offen offset:0 sc1
    v_mfma_f32_16x16x32_bf16 v[60:63], a[44:47], v[40:43], v[60:63]
    v_mfma_f32_16x16x32_bf16 v[64:67], a[48:51], v[40:43], v[64:67]
    v_mfma_f32_16x16x32_bf16 v[68:71], a[52:55], v[40:43], v[68:71]
    v_mfma_f32_16x16x32_bf16 v[72:75], a[56:59], v[40:43], v[72:75]
    buffer_load_dwordx4 a[24:27], v8, s[24:27], s45 offen offset:1024 sc1
    v_mfma_f32_16x16x32_bf16 v[76:79], a[40:43], v[44:47], v[76:79]
    v_mfma_f32_16x16x32_bf16 v[80:83], a[44:47], v[44:47], v[80:83]
    v_mfma_f32_16x16x32_bf16 v[84:87], a[48:51], v[44:47], v[84:87]
    v_mfma_f32_16x16x32_bf16 v[88:91], a[52:55], v[44:47], v[88:91]
    buffer_load_dwordx4 a[28:31], v8, s[24:27], s45 offen offset:2048 sc1
    v_mfma_f32_16x16x32_bf16 v[92:95], a[56:59], v[44:47], v[92:95]
    s_waitcnt vmcnt(13)
    ds_read_b64_tr_b16 v[24:25], v244 offset:0
    v_mfma_f32_16x16x32_bf16 v[96:99], a[40:43], v[48:51], v[96:99]
    ds_read_b64_tr_b16 v[26:27], v244 offset:2048
    v_mfma_f32_16x16x32_bf16 v[100:103], a[44:47], v[48:51], v[100:103]
    ds_read_b64_tr_b16 v[28:29], v245 offset:0
    v_mfma_f32_16x16x32_bf16 v[104:107], a[48:51], v[48:51], v[104:107]
    buffer_load_dwordx4 a[32:35], v8, s[24:27], s45 offen offset:3072 sc1
    ds_read_b64_tr_b16 v[30:31], v245 offset:2048
    v_mfma_f32_16x16x32_bf16 v[108:111], a[52:55], v[48:51], v[108:111]
    ds_read_b64_tr_b16 v[32:33], v246 offset:0
    v_mfma_f32_16x16x32_bf16 v[112:115], a[56:59], v[48:51], v[112:115]
    ds_read_b64_tr_b16 v[34:35], v246 offset:2048
    v_mfma_f32_16x16x32_bf16 v[116:119], a[40:43], v[52:55], v[116:119]
    ds_read_b64_tr_b16 v[36:37], v247 offset:0
    v_mfma_f32_16x16x32_bf16 v[120:123], a[44:47], v[52:55], v[120:123]
    buffer_load_dwordx4 a[36:39], v9, s[24:27], s45 offen sc1
    s_add_u32 s45, s45, 0xa000
    s_cmp_ge_u32 s45, s64
    s_cselect_b32 s3, 0x78000, 0
    s_sub_u32 s45, s45, s3
    ds_read_b64_tr_b16 v[38:39], v247 offset:2048
    v_mfma_f32_16x16x32_bf16 v[124:127], a[48:51], v[52:55], v[124:127]
    v_mfma_f32_16x16x32_bf16 v[128:131], a[52:55], v[52:55], v[128:131]
    v_mfma_f32_16x16x32_bf16 v[132:135], a[56:59], v[52:55], v[132:135]
    s_waitcnt lgkmcnt(0)
    v_mfma_f32_16x16x32_bf16 v[56:59], a[60:63], v[24:27], v[56:59]
    v_mfma_f32_16x16x32_bf16 v[60:63], a[64:67], v[24:27], v[60:63]
    v_mfma_f32_16x16x32_bf16 v[64:67], a[68:71], v[24:27], v[64:67]
    v_mfma_f32_16x16x32_bf16 v[68:71], a[72:75], v[24:27], v[68:71]
    v_mfma_f32_16x16x32_bf16 v[72:75], a[76:79], v[24:27], v[72:75]
    v_mfma_f32_16x16x32_bf16 v[76:79], a[60:63], v[28:31], v[76:79]
    v_mfma_f32_16x16x32_bf16 v[80:83], a[64:67], v[28:31], v[80:83]
    v_mfma_f32_16x16x32_bf16 v[84:87], a[68:71], v[28:31], v[84:87]
    v_mfma_f32_16x16x32_bf16 v[88:91], a[72:75], v[28:31], v[88:91]
    v_mfma_f32_16x16x32_bf16 v[92:95], a[76:79], v[28:31], v[92:95]
    s_waitcnt vmcnt(10)
    ds_read_b64_tr_b16 v[40:41], v244 offset:16384
    v_mfma_f32_16x16x32_bf16 v[96:99], a[60:63], v[32:35], v[96:99]
    ds_read_b64_tr_b16 v[42:43], v244 offset:18432
    v_mfma_f32_16x16x32_bf16 v[100:103], a[64:67], v[32:35], v[100:103]
    ds_read_b64_tr_b16 v[44:45], v245 offset:16384
    v_mfma_f32_16x16x32_bf16 v[104:107], a[68:71], v[32:35], v[104:107]
    ds_read_b64_tr_b16 v[46:47], v245 offset:18432
    v_mfma_f32_16x16x32_bf16 v[108:111], a[72:75], v[32:35], v[108:111]
    ds_read_b64_tr_b16 v[48:49], v246 offset:16384
    v_mfma_f32_16x16x32_bf16 v[112:115], a[76:79], v[32:35], v[112:115]
    ds_read_b64_tr_b16 v[50:51], v246 offset:18432
    v_mfma_f32_16x16x32_bf16 v[116:119], a[60:63], v[36:39], v[116:119]
    ds_read_b64_tr_b16 v[52:53], v247 offset:16384
    v_mfma_f32_16x16x32_bf16 v[120:123], a[64:67], v[36:39], v[120:123]
    ds_read_b64_tr_b16 v[54:55], v247 offset:18432
    v_mfma_f32_16x16x32_bf16 v[124:127], a[68:71], v[36:39], v[124:127]
    v_mfma_f32_16x16x32_bf16 v[128:131], a[72:75], v[36:39], v[128:131]
    v_mfma_f32_16x16x32_bf16 v[132:135], a[76:79], v[36:39], v[132:135]
    s_waitcnt lgkmcnt(0)
    v_mfma_f32_16x16x32_bf16 v[56:59], a[80:83], v[40:43], v[56:59]
    v_mfma_f32_16x16x32_bf16 v[60:63], a[84:87], v[40:43], v[60:63]
    v_mfma_f32_16x16x32_bf16 v[64:67], a[88:91], v[40:43], v[64:67]
    v_mfma_f32_16x16x32_bf16 v[68:71], a[92:95], v[40:43], v[68:71]
    v_mfma_f32_16x16x32_bf16 v[72:75], a[96:99], v[40:43], v[72:75]
    v_mfma_f32_16x16x32_bf16 v[76:79], a[80:83], v[44:47], v[76:79]
    v_mfma_f32_16x16x32_bf16 v[80:83], a[84:87], v[44:47], v[80:83]
    v_mfma_f32_16x16x32_bf16 v[84:87], a[88:91], v[44:47], v[84:87]
    v_mfma_f32_16x16x32_bf16 v[88:91], a[92:95], v[44:47], v[88:91]
    v_mfma_f32_16x16x32_bf16 v[92:95], a[96:99], v[44:47], v[92:95]
    s_waitcnt vmcnt(5)
    ds_read_b64_tr_b16 v[24:25], v18 offset:0
    v_mfma_f32_16x16x32_bf16 v[96:99], a[80:83], v[48:51], v[96:99]
    ds_read_b64_tr_b16 v[26:27], v18 offset:2048
    v_mfma_f32_16x16x32_bf16 v[100:103], a[84:87], v[48:51], v[100:103]
    ds_read_b64_tr_b16 v[28:29], v19 offset:0
    v_mfma_f32_16x16x32_bf16 v[104:107], a[88:91], v[48:51], v[104:107]
    ds_read_b64_tr_b16 v[30:31], v19 offset:2048
    v_mfma_f32_16x16x32_bf16 v[108:111], a[92:95], v[48:51], v[108:111]
    ds_read_b64_tr_b16 v[32:33], v20 offset:0
    v_mfma_f32_16x16x32_bf16 v[112:115], a[96:99], v[48:51], v[112:115]
    ds_read_b64_tr_b16 v[34:35], v20 offset:2048
    v_mfma_f32_16x16x32_bf16 v[116:119], a[80:83], v[52:55], v[116:119]
    ds_read_b64_tr_b16 v[36:37], v21 offset:0
    v_mfma_f32_16x16x32_bf16 v[120:123], a[84:87], v[52:55], v[120:123]
    ds_read_b64_tr_b16 v[38:39], v21 offset:2048
    v_mfma_f32_16x16x32_bf16 v[124:127], a[88:91], v[52:55], v[124:127]
    v_mfma_f32_16x16x32_bf16 v[128:131], a[92:95], v[52:55], v[128:131]
    v_mfma_f32_16x16x32_bf16 v[132:135], a[96:99], v[52:55], v[132:135]
    s_waitcnt lgkmcnt(0)
    v_mfma_f32_16x16x32_bf16 v[56:59], a[0:3], v[24:27], v[56:59]
    v_mfma_f32_16x16x32_bf16 v[60:63], a[4:7], v[24:27], v[60:63]
    v_mfma_f32_16x16x32_bf16 v[64:67], a[8:11], v[24:27], v[64:67]
    v_mfma_f32_16x16x32_bf16 v[68:71], a[12:15], v[24:27], v[68:71]
    v_mfma_f32_16x16x32_bf16 v[72:75], a[16:19], v[24:27], v[72:75]
    v_mfma_f32_16x16x32_bf16 v[76:79], a[0:3], v[28:31], v[76:79]
    v_mfma_f32_16x16x32_bf16 v[80:83], a[4:7], v[28:31], v[80:83]
    v_mfma_f32_16x16x32_bf16 v[84:87], a[8:11], v[28:31], v[84:87]
    v_mfma_f32_16x16x32_bf16 v[88:91], a[12:15], v[28:31], v[88:91]
    v_mfma_f32_16x16x32_bf16 v[92:95], a[16:19], v[28:31], v[92:95]
    s_waitcnt vmcnt(0)
    ds_read_b64_tr_b16 v[40:41], v18 offset:16384
    v_mfma_f32_16x16x32_bf16 v[96:99], a[0:3], v[32:35], v[96:99]
    ds_read_b64_tr_b16 v[42:43], v18 offset:18432
    v_mfma_f32_16x16x32_bf16 v[100:103], a[4:7], v[32:35], v[100:103]
    ds_read_b64_tr_b16 v[44:45], v19 offset:16384
    v_mfma_f32_16x16x32_bf16 v[104:107], a[8:11], v[32:35], v[104:107]
    ds_read_b64_tr_b16 v[46:47], v19 offset:18432
    v_mfma_f32_16x16x32_bf16 v[108:111], a[12:15], v[32:35], v[108:111]
    ds_read_b64_tr_b16 v[48:49], v20 offset:16384
    v_mfma_f32_16x16x32_bf16 v[112:115], a[16:19], v[32:35], v[112:115]
    ds_read_b64_tr_b16 v[50:51], v20 offset:18432
    v_mfma_f32_16x16x32_bf16 v[116:119], a[0:3], v[36:39], v[116:119]
    ds_read_b64_tr_b16 v[52:53], v21 offset:16384
    v_mfma_f32_16x16x32_bf16 v[120:123], a[4:7], v[36:39], v[120:123]
    ds_read_b64_tr_b16 v[54:55], v21 offset:18432
    v_mfma_f32_16x16x32_bf16 v[124:127], a[8:11], v[36:39], v[124:127]
    v_mfma_f32_16x16x32_bf16 v[128:131], a[12:15], v[36:39], v[128:131]
    v_mfma_f32_16x16x32_bf16 v[132:135], a[16:19], v[36:39], v[132:135]
    s_waitcnt lgkmcnt(0)
    v_mfma_f32_16x16x32_bf16 v[56:59], a[20:23], v[40:43], v[56:59]
    v_mfma_f32_16x16x32_bf16 v[60:63], a[24:27], v[40:43], v[60:63]
    v_mfma_f32_16x16x32_bf16 v[64:67], a[28:31], v[40:43], v[64:67]
    v_mfma_f32_16x16x32_bf16 v[68:71], a[32:35], v[40:43], v[68:71]
    v_mfma_f32_16x16x32_bf16 v[72:75], a[36:39], v[40:43], v[72:75]
    v_mfma_f32_16x16x32_bf16 v[76:79], a[20:23], v[44:47], v[76:79]
    v_mfma_f32_16x16x32_bf16 v[80:83], a[24:27], v[44:47], v[80:83]
    v_mfma_f32_16x16x32_bf16 v[84:87], a[28:31], v[44:47], v[84:87]
    v_mfma_f32_16x16x32_bf16 v[88:91], a[32:35], v[44:47], v[88:91]
    v_mfma_f32_16x16x32_bf16 v[92:95], a[36:39], v[44:47], v[92:95]
    v_mfma_f32_16x16x32_bf16 v[96:99], a[20:23], v[48:51], v[96:99]
    v_mfma_f32_16x16x32_bf16 v[100:103], a[24:27], v[48:51], v[100:103]
    v_mfma_f32_16x16x32_bf16 v[104:107], a[28:31], v[48:51], v[104:107]
    v_mfma_f32_16x16x32_bf16 v[108:111], a[32:35], v[48:51], v[108:111]
    v_mfma_f32_16x16x32_bf16 v[112:115], a[36:39], v[48:51], v[112:115]
    v_mfma_f32_16x16x32_bf16 v[116:119], a[20:23], v[52:55], v[116:119]
    v_mfma_f32_16x16x32_bf16 v[120:123], a[24:27], v[52:55], v[120:123]
    v_mfma_f32_16x16x32_bf16 v[124:127], a[28:31], v[52:55], v[124:127]
    v_mfma_f32_16x16x32_bf16 v[128:131], a[32:35], v[52:55], v[128:131]
    v_mfma_f32_16x16x32_bf16 v[132:135], a[36:39], v[52:55], v[132:135]
    s_sub_u32 s49, s44, 0
    s_and_b32 s49, s49, 3
    s_mul_i32 s49, s49, 0x1000
    v_lshl_add_u32 v2, v1, 4, s49
    s_sub_u32 s49, s44, 1
    s_and_b32 s49, s49, 3
    s_mul_i32 s49, s49, 0x1000
    v_lshl_add_u32 v3, v1, 4, s49
    s_sub_u32 s49, s44, 2
    s_and_b32 s49, s49, 3
    s_mul_i32 s49, s49, 0x1000
    v_lshl_add_u32 v4, v1, 4, s49
    s_sub_u32 s49, s44, 3
    s_and_b32 s49, s49, 3
    s_mul_i32 s49, s49, 0x1000
    v_lshl_add_u32 v5, v1, 4, s49
    s_nop 2
    ds_write_b128 v2, v[76:79] offset:0
    ds_write_b128 v2, v[80:83] offset:1024
    ds_write_b128 v2, v[84:87] offset:2048
    ds_write_b128 v2, v[88:91] offset:3072
    ds_write_b128 v2, v[92:95] offset:16384
    ds_write_b128 v2, v[96:99] offset:17408
    ds_write_b128 v2, v[100:103] offset:18432
    ds_write_b128 v2, v[104:107] offset:19456
    ds_write_b128 v2, v[108:111] offset:32768
    ds_write_b128 v2, v[112:115] offset:33792
    ds_write_b128 v2, v[116:119] offset:34816
    ds_write_b128 v2, v[120:123] offset:35840
    ds_write_b128 v2, v[124:127] offset:49152
    ds_write_b128 v2, v[128:131] offset:50176
    ds_write_b128 v2, v[132:135] offset:51200
    s_waitcnt lgkmcnt(0)
    s_barrier
    ds_read_b128 v[76:79], v3 offset:0
    ds_read_b128 v[80:83], v3 offset:1024
    ds_read_b128 v[84:87], v3 offset:2048
    ds_read_b128 v[88:91], v3 offset:3072
    ds_read_b128 v[92:95], v3 offset:16384
    ds_read_b128 v[96:99], v4 offset:17408
    ds_read_b128 v[100:103], v4 offset:18432
    ds_read_b128 v[104:107], v4 offset:19456
    ds_read_b128 v[108:111], v4 offset:32768
    ds_read_b128 v[112:115], v4 offset:33792
    ds_read_b128 v[116:119], v5 offset:34816
    ds_read_b128 v[120:123], v5 offset:35840
    ds_read_b128 v[124:127], v5 offset:49152
    ds_read_b128 v[128:131], v5 offset:50176
    ds_read_b128 v[132:135], v5 offset:51200
    s_waitcnt lgkmcnt(14)
    v_pk_add_f32 v[56:57], v[56:57], v[76:77]
    v_pk_add_f32 v[58:59], v[58:59], v[78:79]
    s_waitcnt lgkmcnt(13)
    v_pk_add_f32 v[60:61], v[60:61], v[80:81]
    v_pk_add_f32 v[62:63], v[62:63], v[82:83]
    s_waitcnt lgkmcnt(12)
    v_pk_add_f32 v[64:65], v[64:65], v[84:85]
    v_pk_add_f32 v[66:67], v[66:67], v[86:87]
    s_waitcnt lgkmcnt(11)
    v_pk_add_f32 v[68:69], v[68:69], v[88:89]
    v_pk_add_f32 v[70:71], v[70:71], v[90:91]
    s_waitcnt lgkmcnt(10)
    v_pk_add_f32 v[72:73], v[72:73], v[92:93]
    v_pk_add_f32 v[74:75], v[74:75], v[94:95]
    s_waitcnt lgkmcnt(9)
    v_pk_add_f32 v[56:57], v[56:57], v[96:97]
    v_pk_add_f32 v[58:59], v[58:59], v[98:99]
    s_waitcnt lgkmcnt(8)
    v_pk_add_f32 v[60:61], v[60:61], v[100:101]
    v_pk_add_f32 v[62:63], v[62:63], v[102:103]
    s_waitcnt lgkmcnt(7)
    v_pk_add_f32 v[64:65], v[64:65], v[104:105]
    v_pk_add_f32 v[66:67], v[66:67], v[106:107]
    s_waitcnt lgkmcnt(6)
    v_pk_add_f32 v[68:69], v[68:69], v[108:109]
    v_pk_add_f32 v[70:71], v[70:71], v[110:111]
    s_waitcnt lgkmcnt(5)
    v_pk_add_f32 v[72:73], v[72:73], v[112:113]
    v_pk_add_f32 v[74:75], v[74:75], v[114:115]
    s_waitcnt lgkmcnt(4)
    v_pk_add_f32 v[56:57], v[56:57], v[116:117]
    v_pk_add_f32 v[58:59], v[58:59], v[118:119]
    s_waitcnt lgkmcnt(3)
    v_pk_add_f32 v[60:61], v[60:61], v[120:121]
    v_pk_add_f32 v[62:63], v[62:63], v[122:123]
    s_waitcnt lgkmcnt(2)
    v_pk_add_f32 v[64:65], v[64:65], v[124:125]
    v_pk_add_f32 v[66:67], v[66:67], v[126:127]
    s_waitcnt lgkmcnt(1)
    v_pk_add_f32 v[68:69], v[68:69], v[128:129]
    v_pk_add_f32 v[70:71], v[70:71], v[130:131]
    s_waitcnt lgkmcnt(0)
    v_pk_add_f32 v[72:73], v[72:73], v[132:133]
    v_pk_add_f32 v[74:75], v[74:75], v[134:135]
    s_mov_b32 s40, s20
    s_mov_b32 s41, s21
    s_mov_b32 s42, 0x280000
    s_mov_b32 s43, 0x00020000
    v_lshlrev_b32 v22, 16, v144
    v_mov_b32 v23, v22
    s_lshl_b32 s49, s52, 6
    s_lshl_b32 s60, s44, 4
    s_add_u32 s49, s49, s60
    s_mul_i32 s49, s49, 1280
    s_mul_i32 s60, s53, 160
    s_add_u32 s49, s49, s60
    v_lshrrev_b32 v2, 4, v1
    v_lshlrev_b32 v2, 3, v2
    s_movk_i32 s60, 1280
    v_mad_u32_u24 v2, v7, s60, v2

    v_pk_add_f32 v[56:57], v[56:57], v[22:23]
    v_pk_add_f32 v[58:59], v[58:59], v[22:23]
    v_cvt_pk_bf16_f32 v24, v56, v57
    v_cvt_pk_bf16_f32 v25, v58, v59
    buffer_store_dwordx2 v[24:25], v2, s[40:43], s49 offen offset:0

    v_pk_add_f32 v[60:61], v[60:61], v[22:23]
    v_pk_add_f32 v[62:63], v[62:63], v[22:23]
    v_cvt_pk_bf16_f32 v26, v60, v61
    v_cvt_pk_bf16_f32 v27, v62, v63
    buffer_store_dwordx2 v[26:27], v2, s[40:43], s49 offen offset:32

    v_pk_add_f32 v[64:65], v[64:65], v[22:23]
    v_pk_add_f32 v[66:67], v[66:67], v[22:23]
    v_cvt_pk_bf16_f32 v28, v64, v65
    v_cvt_pk_bf16_f32 v29, v66, v67
    buffer_store_dwordx2 v[28:29], v2, s[40:43], s49 offen offset:64

    v_pk_add_f32 v[68:69], v[68:69], v[22:23]
    v_pk_add_f32 v[70:71], v[70:71], v[22:23]
    v_cvt_pk_bf16_f32 v30, v68, v69
    v_cvt_pk_bf16_f32 v31, v70, v71
    buffer_store_dwordx2 v[30:31], v2, s[40:43], s49 offen offset:96

    v_pk_add_f32 v[72:73], v[72:73], v[22:23]
    v_pk_add_f32 v[74:75], v[74:75], v[22:23]
    v_cvt_pk_bf16_f32 v32, v72, v73
    v_cvt_pk_bf16_f32 v33, v74, v75
    buffer_store_dwordx2 v[32:33], v2, s[40:43], s49 offen offset:128

L_end:
    s_endpgm
.section .rodata,"a"
.p2align 6
.amdhsa_kernel sequential_preLN__sliding_local_dilated__mixer_token_mlp__prompt_kernel
  .amdhsa_next_free_vgpr 512
  .amdhsa_next_free_sgpr 102
  .amdhsa_accum_offset 256
  .amdhsa_group_segment_fixed_size 0
  .amdhsa_kernarg_size 88
  .amdhsa_user_sgpr_count 2
  .amdhsa_user_sgpr_kernarg_segment_ptr 1
  .amdhsa_system_sgpr_workgroup_id_x 1
.end_amdhsa_kernel
```
